```python
import torch

def _softmax(x, axis=-1):
    return torch.softmax(x, dim=axis)
def _gelu(x):
    return torch.nn.functional.gelu(x, approximate="tanh")
def _silu(x):
    return torch.nn.functional.silu(x)
def _sigmoid(x):
    return torch.sigmoid(x)
def _layernorm(x, axis=-1, eps=1e-5):
    m = x.mean(dim=axis, keepdim=True)
    v = x.var(dim=axis, keepdim=True, unbiased=False)
    return (x - m) / torch.sqrt(v + eps)
def _scatter_add(tgt, idx, src, axis=0):
    return tgt.clone().index_add_(axis, idx, src)
def _segment_sum(src, seg, n):
    out = torch.zeros((n,) + src.shape[1:], dtype=src.dtype)
    return out.index_add_(0, seg, src)
def _pad(x, pw):
    flat = tuple(v for pair in reversed(pw) for v in pair)
    return torch.nn.functional.pad(x, flat)

kernel_name = 'recurrent_scan__sliding_block__mixer_channel_mlp__prompt'

def setup_inputs():

    _w = (lambda a: (lambda t: t.to(torch.bfloat16) if t.is_floating_point() else t)(torch.as_tensor(a)))
    def _A_setup():
        B, S, D = 1, 2048, 512
        return {
            "x": _w((lambda *s: torch.randn(*s, dtype=torch.bfloat16) * 0.05)(B, S, D)),
            "wqkv": _w((lambda *s: torch.randn(*s, dtype=torch.bfloat16) * 0.05)(D, 3 * D)),
            "wo": _w((lambda *s: torch.randn(*s, dtype=torch.bfloat16) * 0.05)(D, D)),
        }
    _A_in = _A_setup()

    def _B_setup():
        B, S, D, F = 1, 2048, 512, 1792
        return {
            "x": _w((lambda *s: torch.randn(*s, dtype=torch.bfloat16) * 0.05)(B, S, D)),
            "w1": _w((lambda *s: torch.randn(*s, dtype=torch.bfloat16) * 1.6)(D, F) * (D ** -0.5)),
            "b1": _w((lambda *s: torch.randn(*s, dtype=torch.bfloat16) * 0.8)(F)),
            "w2": _w((lambda *s: torch.randn(*s, dtype=torch.bfloat16) * 0.05)(F, D) * (F ** -0.5)),
            "b2": _w((lambda *s: torch.randn(*s, dtype=torch.bfloat16) * 0.05)(D)),
        }
    _B_in = _B_setup()

    return {
        "A_x": _A_in["x"],
        "A_wqkv": _A_in["wqkv"],
        "A_wo": _A_in["wo"],
        "B_x": _B_in["x"],
        "B_w1": _B_in["w1"],
        "B_b1": _B_in["b1"],
        "B_w2": _B_in["w2"],
        "B_b2": _B_in["b2"],
    }

def reference(A_x, A_wqkv, A_wo, B_x, B_w1, B_b1, B_w2, B_b2):
    def _A_ref(x, wqkv, wo):
        B, S, D = x.shape
        H = 32; Dh = D // H; W = 256
        qkv = (lambda x, *d: x.permute(*d))((x @ wqkv).reshape(B, S, 3, H, Dh), 2, 0, 3, 1, 4)
        q, k, v = qkv[0], qkv[1], qkv[2]
        scores = torch.einsum("bhqd,bhkd->bhqk", q, k) * (Dh ** -0.5)
        idx = torch.arange(S)
        mask = (idx[:, None] - idx[None, :] >= 0) & (idx[:, None] - idx[None, :] < W)
        scores = torch.where(mask[None, None], scores, -1e9)
        p = _softmax(scores, axis=-1)
        o = torch.einsum("bhqk,bhkd->bhqd", p, v)
        return (lambda x, *d: x.permute(*d))(o, 0, 2, 1, 3).reshape(B, S, D) @ wo

    def _B_ref(x, w1, b1, w2, b2):
        y = _layernorm(x, axis=-1)
        h = _gelu(torch.einsum("bsd,df->bsf", y, w1) + b1)
        return torch.einsum("bsf,fd->bsd", h, w2) + b2

    x = A_x
    xn = _layernorm(x, axis=-1)
    s = _A_ref(xn, A_wqkv, A_wo)
    g = _silu(_B_ref(xn, B_w1, B_b1, B_w2, B_b2))
    return x + s * g
```

```asm
; @launch grid=(256,1,1) block=(512,1,1) lds=163840
.amdgcn_target "amdgcn-amd-amdhsa--gfx950"
.text
.globl recurrent_scan__sliding_block__mixer_channel_mlp__prompt_kernel
.p2align 8
.type recurrent_scan__sliding_block__mixer_channel_mlp__prompt_kernel,@function
recurrent_scan__sliding_block__mixer_channel_mlp__prompt_kernel:
  s_cmp_ge_u32 s2, 256
  s_cbranch_scc1 L_end
  s_load_dwordx2 s[4:5], s[0:1], 0
  s_load_dwordx2 s[8:9], s[0:1], 8
  s_load_dwordx2 s[16:17], s[0:1], 32
  s_load_dwordx2 s[20:21], s[0:1], 80
  s_load_dwordx2 s[40:41], s[0:1], 72
  s_load_dwordx2 s[36:37], s[0:1], 40
  s_load_dwordx2 s[24:25], s[0:1], 48
  s_load_dwordx2 s[28:29], s[0:1], 16
  s_load_dwordx2 s[32:33], s[0:1], 64
  s_load_dwordx2 s[38:39], s[0:1], 56
  v_lshrrev_b32 v2, 6, v0
  v_and_b32 v1, 63, v0
  v_readfirstlane_b32 s42, v2
  s_getpc_b64 s[52:53]
  L_pc:
  s_lshr_b32 s54, s2, 3
  s_mul_i32 s54, s54, 896
  v_lshlrev_b32 v3, 7, v1
  v_add_u32 v3, s54, v3
    v_min_u32 v3, L_codeend-L_pc, v3
  v_cmp_gt_u32 vcc, 7, v0
  s_nop 0
  s_and_saveexec_b64 s[54:55], vcc
  s_nop 2
  s_cbranch_execz L_nopf_1
    global_load_dword v247, v3, s[52:53]
L_nopf_1:
  s_mov_b64 exec, -1
  s_lshr_b32 s97, s2, 5
  s_and_b32 s98, s2, 4
  s_lshl1_add_u32 s45, s98, s97
  s_mov_b32 s6, 2097152
  s_mov_b32 s7, 0x00020000
  v_lshrrev_b32 v110, 3, v1
  v_lshrrev_b32 v111, 4, v1
  v_and_b32 v112, 7, v1
  v_xor_b32 v113, v112, v111
  v_lshlrev_b32 v114, 10, v110
  v_lshl_add_u32 v14, v113, 4, v114
  s_movk_i32 s99, 0x2000
  v_xad_u32 v15, v14, 64, s99
  v_lshlrev_b32 v127, 4, v1
  s_lshl_b32 s78, s45, 17
  s_lshl_b32 s99, s42, 14
  s_add_u32 s78, s78, s99
  s_lshl_b32 s97, s42, 11
  s_mov_b32 s73, 0
  s_waitcnt lgkmcnt(0)
  s_cmp_lg_u32 s2, 0
  s_cbranch_scc1 L_noclr_2
    s_mov_b32 s22, 16826368
    s_mov_b32 s23, 0x00020000
    v_mov_b32 v118, 0
    v_mov_b32 v119, 0
    v_mov_b32 v120, 0
    v_mov_b32 v121, 0
    s_lshl_b32 s99, s42, 12
    s_add_u32 s99, s99, 15728640
    buffer_store_dwordx4 v[118:121], v127, s[20:23], s99 offen offset:0 sc1
    buffer_store_dwordx4 v[118:121], v127, s[20:23], s99 offen offset:1024 sc1
    buffer_store_dwordx4 v[118:121], v127, s[20:23], s99 offen offset:2048 sc1
    buffer_store_dwordx4 v[118:121], v127, s[20:23], s99 offen offset:3072 sc1
    s_nop 1
    v_mov_b32 v114, -1.0
    v_mov_b32 v115, -1.0
    v_mov_b32 v116, -1.0
    v_mov_b32 v117, -1.0
    s_add_u32 s99, s97, 15761408
    buffer_store_dwordx4 v[114:117], v127, s[20:23], s99 offen offset:0 sc1
    buffer_store_dwordx4 v[114:117], v127, s[20:23], s99 offen offset:1024 sc1
    s_nop 1
L_noclr_2:
  s_add_u32 m0, s97, 0
  s_add_u32 s99, s78, 0
  buffer_load_dwordx4 v14, s[4:7], s99 offen lds
  s_add_u32 m0, s97, 1024
  s_add_u32 s99, s78, 0
  buffer_load_dwordx4 v15, s[4:7], s99 offen lds
  s_and_b32 s46, s2, 3
  s_bfe_u32 s47, s2, 0x20003
  s_mov_b32 s10, 1572864
  s_mov_b32 s11, 0x00020000
  s_mov_b32 s18, 1835008
  s_mov_b32 s19, 0x00020000
  s_mov_b32 s22, 16826368
  s_mov_b32 s23, 0x00020000
  s_lshl_b32 s98, s42, 10
  s_lshl_b32 s52, s47, 1
  s_add_u32 s53, s47, 2
  s_min_u32 s53, s52, s53
  s_mul_i32 s48, s46, 6
  s_add_u32 s48, s48, s53
  s_sub_u32 s52, s52, 1
  s_max_i32 s52, s52, s47
  s_mul_i32 s51, s46, 7
  s_add_u32 s50, s51, s52
  s_add_u32 s51, s51, 6
  s_add_u32 s52, s48, 1
  s_sub_u32 s53, s50, 1
  s_movk_i32 s54, 3584
  s_movk_i32 s56, 3072
  s_cmp_lt_u32 s47, 2
  s_cselect_b32 s49, s52, s53
  s_cselect_b32 s96, 0, 1
  s_cselect_b32 s81, s56, s54
  s_cselect_b32 s14, s10, s18
  s_cselect_b32 s12, s8, s16
  s_cselect_b32 s13, s9, s17
  s_mov_b32 s15, 0x00020000
  v_lshlrev_b32 v112, 4, v112
  v_and_b32 v111, 1, v111
  v_lshlrev_b32 v111, 6, v111
  v_xor_b32 v112, v112, v111
  v_mad_u32_u24 v16, v110, s56, v112
  v_mad_u32_u24 v17, v110, s54, v112
  v_mad_u32_u24 v18, v110, s81, v112
  s_lshl_b32 s79, s48, 7
  s_mul_i32 s99, s42, 24576
  s_add_u32 s79, s79, s99
  s_lshl_b32 s99, s42, 3
  s_mul_i32 s99, s99, s81
  s_lshl_b32 s80, s49, 7
  s_add_u32 s80, s80, s99
  s_lshl_b32 s81, s81, 6
  s_lshl2_add_u32 s100, s46, s47
  s_lshl_b32 s100, s100, 3
  s_add_u32 s100, s100, s42
  s_lshl_b32 s55, s45, 7
  s_add_u32 s55, s55, s100
  s_lshl_b32 s100, s55, 10
  s_add_u32 m0, s98, 16384
  s_add_u32 s99, s79, 0
  buffer_load_dwordx4 v16, s[8:11], s99 offen lds
  s_add_u32 m0, s98, 24576
  s_mul_i32 s99, s81, 0
  s_add_u32 s99, s99, s80
  buffer_load_dwordx4 v18, s[12:15], s99 offen lds
  buffer_load_dwordx4 v[252:255], v127, s[4:7], s100 offen
  s_add_u32 m0, s97, 32768
  s_add_u32 s99, s78, 128
  buffer_load_dwordx4 v14, s[4:7], s99 offen lds
  s_add_u32 m0, s97, 33792
  s_add_u32 s99, s78, 128
  buffer_load_dwordx4 v15, s[4:7], s99 offen lds
  s_add_u32 m0, s98, 49152
  s_add_u32 s99, s79, 196608
  buffer_load_dwordx4 v16, s[8:11], s99 offen lds
  s_add_u32 m0, s98, 57344
  s_mul_i32 s99, s81, 1
  s_add_u32 s99, s99, s80
  buffer_load_dwordx4 v18, s[12:15], s99 offen lds
  s_and_b32 s43, s42, 3
  s_lshr_b32 s44, s42, 2
  s_xor_b32 s99, s43, s44
  v_lshrrev_b32 v111, 5, v1
  v_bfe_u32 v112, v1, 1, 3
  v_xor_b32 v112, v112, v111
  s_lshl_b32 s100, s99, 1
  v_xor_b32 v112, s100, v112
  v_and_b32 v110, 31, v1
  v_lshlrev_b32 v113, 7, v110
  v_lshl_add_u32 v113, v112, 4, v113
  s_lshl_b32 s100, s43, 12
  v_add_u32 v6, s100, v113
  v_xor_b32 v7, 32, v6
  v_xor_b32 v8, 64, v6
  v_xor_b32 v9, 96, v6
  v_and_b32 v112, 3, v1
  v_lshlrev_b32 v112, 3, v112
  v_bfe_u32 v113, v1, 4, 1
  v_lshl_or_b32 v112, v113, 5, v112
  v_bfe_u32 v113, v1, 3, 1
  v_xor_b32 v113, s44, v113
  v_lshl_or_b32 v112, v113, 6, v112
  v_bfe_u32 v113, v1, 2, 2
  v_lshl_or_b32 v112, v113, 7, v112
  v_lshl_or_b32 v112, v111, 10, v112
  s_lshl_b32 s100, s99, 11
  v_or_b32 v10, s100, v112
  v_xor_b32 v11, 0x00000800, v10
  v_xor_b32 v12, 0x00001000, v10
  v_xor_b32 v13, 0x00001800, v10
  s_mov_b32 s52, 0x10100101
  s_mov_b32 s53, 0x10100101
  v_mov_b32 v114, 0x3f803f80
  v_cndmask_b32 v2, 0, v114, s[52:53]
  v_cndmask_b32 v3, 0, v114, s[52:53]
  v_cndmask_b32 v4, 0, v114, s[52:53]
  v_cndmask_b32 v5, 0, v114, s[52:53]
  s_waitcnt vmcnt(4)
  v_dot2_f32_bf16 v248, v252, v114, 0
  v_dot2_f32_bf16 v249, v252, v252, 0
  v_dot2_f32_bf16 v248, v253, v114, v248
  v_dot2_f32_bf16 v249, v253, v253, v249
  v_dot2_f32_bf16 v248, v254, v114, v248
  v_dot2_f32_bf16 v249, v254, v254, v249
  v_dot2_f32_bf16 v248, v255, v114, v248
  v_dot2_f32_bf16 v249, v255, v255, v249
  v_mov_b32 v126, 0
  s_add_u32 m0, s97, 65536
  s_add_u32 s99, s78, 256
  buffer_load_dwordx4 v14, s[4:7], s99 offen lds
  s_add_u32 m0, s97, 66560
  s_add_u32 s99, s78, 256
  buffer_load_dwordx4 v15, s[4:7], s99 offen lds
  s_add_u32 m0, s98, 81920
  s_add_u32 s99, s79, 393216
  buffer_load_dwordx4 v16, s[8:11], s99 offen lds
  s_add_u32 m0, s98, 90112
  s_mul_i32 s99, s81, 2
  s_add_u32 s99, s99, s80
  buffer_load_dwordx4 v18, s[12:15], s99 offen lds
  s_cmp_lg_u32 s42, 6
  s_cbranch_scc1 L_notouch1_3
    v_lshrrev_b32 v118, 1, v1
    s_lshl_b32 s100, s45, 5
    v_add_u32 v118, s100, v118
    s_movk_i32 s100, 3584
    v_mul_lo_u32 v118, v118, s100
    v_and_b32 v119, 1, v1
    s_sub_u32 s100, s51, s50
    s_lshl_b32 s100, s100, 7
    v_mul_u32_u24 v119, s100, v119
    v_add_u32 v118, v118, v119
    s_lshl_b32 s100, s50, 7
    buffer_load_dword v246, v118, s[16:19], s100 offen
L_notouch1_3:
  s_barrier
  s_cmp_lg_u32 s42, 0
  s_cbranch_scc1 L_ow_4
  s_cmp_lg_u32 s2, 0
  s_cbranch_scc1 L_nogo_5
    v_mov_b32 v118, 0
    v_mov_b32 v119, 1
    s_mov_b64 exec, 1
    global_store_dword v118, v119, s[40:41] sc1
    s_mov_b64 exec, -1
L_nogo_5:
L_ow_4:
  ds_read_b128 v[128:131], v6 offset:0
  ds_read_b64_tr_b16 v[32:33], v10 offset:16384
  ds_read_b64_tr_b16 v[34:35], v10 offset:16896
  ds_read_b64_tr_b16 v[36:37], v10 offset:24576
  ds_read_b64_tr_b16 v[38:39], v10 offset:25088
  ds_read_b128 v[132:135], v7 offset:0
  ds_read_b64_tr_b16 v[40:41], v11 offset:16384
  ds_read_b64_tr_b16 v[42:43], v11 offset:16896
  ds_read_b64_tr_b16 v[44:45], v11 offset:24576
  ds_read_b64_tr_b16 v[46:47], v11 offset:25088
  s_waitcnt lgkmcnt(7)
  v_mfma_f32_32x32x16_bf16 v[48:63], v[32:35], v[128:131], 0
  ds_read_b128 v[136:139], v8 offset:0
  ds_read_b64_tr_b16 v[80:81], v12 offset:16384
  ds_read_b64_tr_b16 v[82:83], v12 offset:16896
  v_add_f32_dpp v248, v248, v248 row_shr:1 row_mask:0xf bank_mask:0xf bound_ctrl:0
  v_add_f32_dpp v249, v249, v249 row_shr:1 row_mask:0xf bank_mask:0xf bound_ctrl:0
  s_waitcnt lgkmcnt(8)
  v_mfma_f32_32x32x16_bf16 v[64:79], v[36:39], v[128:131], 0
  ds_read_b64_tr_b16 v[84:85], v12 offset:24576
  ds_read_b64_tr_b16 v[86:87], v12 offset:25088
  s_add_u32 m0, s97, 98304
  s_add_u32 s99, s78, 384
  buffer_load_dwordx4 v14, s[4:7], s99 offen lds
  v_add_f32_dpp v248, v248, v248 row_shr:2 row_mask:0xf bank_mask:0xf bound_ctrl:0
  v_add_f32_dpp v249, v249, v249 row_shr:2 row_mask:0xf bank_mask:0xf bound_ctrl:0
  v_mfma_f32_16x16x32_bf16 v[24:27], v[2:5], v[32:35], 0
  s_mov_b32 s26, 1835008
  s_mov_b32 s27, 0x00020000
  s_mov_b32 s30, 524288
  s_mov_b32 s31, 0x00020000
  s_mov_b32 s34, 2097152
  s_mov_b32 s35, 0x00020000
  s_and_b32 s88, s2, 7
  s_lshr_b32 s89, s2, 3
  s_mov_b32 s76, -1
  s_mov_b32 s77, 0
  v_add_f32_dpp v248, v248, v248 row_shr:4 row_mask:0xf bank_mask:0xf bound_ctrl:0
  v_mfma_f32_16x16x32_bf16 v[28:31], v[2:5], v[36:39], 0
  ds_read_b128 v[140:143], v9 offset:0
  ds_read_b64_tr_b16 v[88:89], v13 offset:16384
  ds_read_b64_tr_b16 v[90:91], v13 offset:16896
  s_add_u32 m0, s97, 99328
  s_add_u32 s99, s78, 384
  buffer_load_dwordx4 v15, s[4:7], s99 offen lds
  v_add_f32_dpp v249, v249, v249 row_shr:4 row_mask:0xf bank_mask:0xf bound_ctrl:0
  v_add_f32_dpp v248, v248, v248 row_shr:8 row_mask:0xf bank_mask:0xf bound_ctrl:0
  s_waitcnt lgkmcnt(10)
  v_mfma_f32_32x32x16_bf16 v[48:63], v[40:43], v[132:135], v[48:63]
  ds_read_b64_tr_b16 v[92:93], v13 offset:24576
  ds_read_b64_tr_b16 v[94:95], v13 offset:25088
  v_add_f32_dpp v249, v249, v249 row_shr:8 row_mask:0xf bank_mask:0xf bound_ctrl:0
  v_add_f32_dpp v248, v248, v248 row_bcast:15 row_mask:0xa bank_mask:0xf
  s_waitcnt lgkmcnt(10)
  v_mfma_f32_32x32x16_bf16 v[64:79], v[44:47], v[132:135], v[64:79]
  s_add_u32 m0, s98, 114688
  s_add_u32 s99, s79, 589824
  buffer_load_dwordx4 v16, s[8:11], s99 offen lds
  v_add_f32_dpp v249, v249, v249 row_bcast:15 row_mask:0xa bank_mask:0xf
  v_add_f32_dpp v248, v248, v248 row_bcast:31 row_mask:0xc bank_mask:0xf
  s_waitcnt vmcnt(7)
  s_barrier
  s_waitcnt lgkmcnt(7)
  v_mfma_f32_32x32x16_bf16 v[48:63], v[80:83], v[136:139], v[48:63]
  ds_read_b128 v[144:147], v6 offset:32768
  ds_read_b64_tr_b16 v[32:33], v10 offset:49152
  ds_read_b64_tr_b16 v[34:35], v10 offset:49664
  v_add_f32_dpp v249, v249, v249 row_bcast:31 row_mask:0xc bank_mask:0xf
  s_waitcnt lgkmcnt(8)
  v_mfma_f32_32x32x16_bf16 v[64:79], v[84:87], v[136:139], v[64:79]
  ds_read_b64_tr_b16 v[36:37], v10 offset:57344
  ds_read_b64_tr_b16 v[38:39], v10 offset:57856
  v_mul_f32 v250, 0x3b000000, v248
  v_mul_f32 v249, 0x3b000000, v249
  s_waitcnt lgkmcnt(7)
  v_mfma_f32_32x32x16_bf16 v[48:63], v[88:91], v[140:143], v[48:63]
  ds_read_b128 v[148:151], v7 offset:32768
  ds_read_b64_tr_b16 v[40:41], v11 offset:49152
  ds_read_b64_tr_b16 v[42:43], v11 offset:49664
  s_add_u32 m0, s98, 122880
  s_mul_i32 s99, s81, 3
  s_add_u32 s99, s99, s80
  buffer_load_dwordx4 v18, s[12:15], s99 offen lds
  v_fma_f32 v249, -v250, v250, v249
  v_max_f32 v251, 0, v249
  s_waitcnt lgkmcnt(8)
  v_mfma_f32_32x32x16_bf16 v[64:79], v[92:95], v[140:143], v[64:79]
  ds_read_b64_tr_b16 v[44:45], v11 offset:57344
  ds_read_b64_tr_b16 v[46:47], v11 offset:57856
  s_mov_b32 s74, 0xffff0000
  s_lshl_b32 s82, s50, 7
  s_mul_i32 s100, s42, 28672
  s_add_u32 s82, s82, s100
  s_lshl_b32 s83, s51, 7
  s_and_b32 s100, s47, 1
  s_waitcnt lgkmcnt(7)
  v_mfma_f32_32x32x16_bf16 v[48:63], v[32:35], v[144:147], v[48:63]
  s_lshl_b32 s100, s100, 6
  s_add_u32 s83, s83, s100
  s_add_u32 s100, s42, s73
  s_and_b32 s100, s100, 7
  s_mul_i32 s100, s100, 229376
  s_add_u32 s83, s83, s100
  ds_read_b128 v[152:155], v8 offset:32768
  ds_read_b64_tr_b16 v[80:81], v12 offset:49152
  ds_read_b64_tr_b16 v[82:83], v12 offset:49664
  s_waitcnt lgkmcnt(8)
  v_mfma_f32_32x32x16_bf16 v[64:79], v[36:39], v[144:147], v[64:79]
  v_lshrrev_b32 v114, 2, v1
  ds_read_b64_tr_b16 v[84:85], v12 offset:57344
  ds_read_b64_tr_b16 v[86:87], v12 offset:57856
  s_add_u32 m0, s97, 131072
  s_add_u32 s99, s78, 512
  buffer_load_dwordx4 v14, s[4:7], s99 offen lds
  v_mfma_f32_16x16x32_bf16 v[24:27], v[2:5], v[32:35], v[24:27]
  v_and_b32 v115, 3, v1
  v_lshlrev_b32 v115, 4, v115
  v_mfma_f32_16x16x32_bf16 v[28:31], v[2:5], v[36:39], v[28:31]
  s_movk_i32 s100, 3584
  v_mad_u32_u24 v19, v114, s100, v115
  s_lshl_b32 s100, s96, 30
  ds_read_b128 v[156:159], v9 offset:32768
  ds_read_b64_tr_b16 v[88:89], v13 offset:49152
  ds_read_b64_tr_b16 v[90:91], v13 offset:49664
  s_add_u32 m0, s97, 132096
  s_add_u32 s99, s78, 512
  buffer_load_dwordx4 v15, s[4:7], s99 offen lds
  s_waitcnt lgkmcnt(10)
  v_mfma_f32_32x32x16_bf16 v[48:63], v[40:43], v[148:151], v[48:63]
  v_add_u32 v19, s100, v19
  ds_read_b64_tr_b16 v[92:93], v13 offset:57344
  ds_read_b64_tr_b16 v[94:95], v13 offset:57856
  s_waitcnt lgkmcnt(10)
  v_mfma_f32_32x32x16_bf16 v[64:79], v[44:47], v[148:151], v[64:79]
  v_and_b32 v114, 31, v1
  s_lshl_b32 s100, s44, 5
  v_add_lshl_u32 v115, s100, v114, 1
  s_add_u32 m0, s98, 147456
  s_add_u32 s99, s79, 786432
  buffer_load_dwordx4 v16, s[8:11], s99 offen lds
  s_waitcnt vmcnt(7)
  s_barrier
  s_waitcnt lgkmcnt(7)
  v_mfma_f32_32x32x16_bf16 v[48:63], v[80:83], v[152:155], v[48:63]
  s_mul_i32 s100, s49, s96
  s_lshl_b32 s100, s100, 7
  v_add_u32 v116, s100, v115
  v_add_u32 v6, 0x00010000, v6
  v_add_u32 v10, 0x00010000, v10
  ds_read_b128 v[160:163], v6 offset:0
  ds_read_b64_tr_b16 v[32:33], v10 offset:16384
  ds_read_b64_tr_b16 v[34:35], v10 offset:16896
  s_waitcnt lgkmcnt(8)
  v_mfma_f32_32x32x16_bf16 v[64:79], v[84:87], v[152:155], v[64:79]
  global_load_ushort v107, v116, s[36:37]
  s_lshl_b32 s100, s50, 7
  ds_read_b64_tr_b16 v[36:37], v10 offset:24576
  ds_read_b64_tr_b16 v[38:39], v10 offset:25088
  s_cmp_lg_u32 s42, 7
  s_nop 6
  s_cbranch_scc1 L_notouch_6
    s_mul_i32 s3, s2, 7168
    v_lshlrev_b32 v118, 7, v1
    v_min_u32 v119, 7040, v118
    buffer_load_dword v120, v119, s[24:27], s3 offen
    s_lshl_b32 s3, s2, 11
    v_and_b32 v118, 0x780, v118
    buffer_load_dword v121, v118, s[28:31], s3 offen
L_notouch_6:
  s_waitcnt lgkmcnt(7)
  v_mfma_f32_32x32x16_bf16 v[48:63], v[88:91], v[156:159], v[48:63]
  v_add_u32 v117, s100, v115
  v_add_u32 v7, 0x00010000, v7
  v_add_u32 v11, 0x00010000, v11
  ds_read_b128 v[164:167], v7 offset:0
  ds_read_b64_tr_b16 v[40:41], v11 offset:16384
  ds_read_b64_tr_b16 v[42:43], v11 offset:16896
  s_add_u32 m0, s98, 155648
  s_mul_i32 s99, s81, 4
  s_add_u32 s99, s99, s80
  buffer_load_dwordx4 v18, s[12:15], s99 offen lds
  s_waitcnt lgkmcnt(8)
  v_mfma_f32_32x32x16_bf16 v[64:79], v[92:95], v[156:159], v[64:79]
  global_load_ushort v108, v117, s[36:37]
  s_and_b32 s100, s47, 1
  s_lshl1_add_u32 s100, s51, s100
  s_lshl_b32 s100, s100, 6
  ds_read_b64_tr_b16 v[44:45], v11 offset:24576
  ds_read_b64_tr_b16 v[46:47], v11 offset:25088
  s_waitcnt lgkmcnt(7)
  v_mfma_f32_32x32x16_bf16 v[48:63], v[32:35], v[160:163], v[48:63]
  v_lshlrev_b32 v116, 1, v114
  v_add_u32 v116, s100, v116
  v_add_u32 v8, 0x00010000, v8
  v_add_u32 v12, 0x00010000, v12
  ds_read_b128 v[168:171], v8 offset:0
  ds_read_b64_tr_b16 v[80:81], v12 offset:16384
  ds_read_b64_tr_b16 v[82:83], v12 offset:16896
  s_waitcnt lgkmcnt(8)
  v_mfma_f32_32x32x16_bf16 v[64:79], v[36:39], v[160:163], v[64:79]
  global_load_ushort v109, v116, s[36:37]
  s_lshl_b32 s100, s44, 9
  ds_read_b64_tr_b16 v[84:85], v12 offset:24576
  ds_read_b64_tr_b16 v[86:87], v12 offset:25088
  s_add_u32 m0, s97, 0
  s_add_u32 s99, s78, 640
  buffer_load_dwordx4 v14, s[4:7], s99 offen lds
  v_mfma_f32_16x16x32_bf16 v[24:27], v[2:5], v[32:35], v[24:27]
  s_add_u32 s100, s100, 81920
  v_lshlrev_b32 v115, 4, v114
  v_mfma_f32_16x16x32_bf16 v[28:31], v[2:5], v[36:39], v[28:31]
  v_add_u32 v125, s100, v115
  s_lshl_b32 s100, s43, 2
  v_add_u32 v9, 0x00010000, v9
  v_add_u32 v13, 0x00010000, v13
  ds_read_b128 v[172:175], v9 offset:0
  ds_read_b64_tr_b16 v[88:89], v13 offset:16384
  ds_read_b64_tr_b16 v[90:91], v13 offset:16896
  s_add_u32 m0, s97, 1024
  s_add_u32 s99, s78, 640
  buffer_load_dwordx4 v15, s[4:7], s99 offen lds
  s_waitcnt lgkmcnt(10)
  v_mfma_f32_32x32x16_bf16 v[48:63], v[40:43], v[164:167], v[48:63]
  v_add_u32 v123, s100, v125
  v_lshlrev_b32 v122, 3, v114
  ds_read_b64_tr_b16 v[92:93], v13 offset:24576
  ds_read_b64_tr_b16 v[94:95], v13 offset:25088
  s_waitcnt lgkmcnt(10)
  v_mfma_f32_32x32x16_bf16 v[64:79], v[44:47], v[164:167], v[64:79]
  s_lshl2_add_u32 s56, s45, s43
  s_lshl_b32 s57, s56, 8
  s_add_u32 s57, s57, 15761408
  s_lshl_b32 s100, s44, 1
  s_lshl2_add_u32 s84, s48, s100
  s_lshl_b32 s84, s84, 6
  s_add_u32 m0, s98, 16384
  s_add_u32 s99, s79, 983040
  buffer_load_dwordx4 v16, s[8:11], s99 offen lds
  s_waitcnt vmcnt(10)
  s_barrier
  s_waitcnt lgkmcnt(7)
  v_mfma_f32_32x32x16_bf16 v[48:63], v[80:83], v[168:171], v[48:63]
  s_add_u32 s84, s84, s56
  s_lshl_b32 s84, s84, 10
  s_add_u32 s52, s84, 65536
  s_add_u32 s54, s84, 262144
  s_add_u32 s53, s84, 327680
  s_mul_i32 s58, s56, 112
  ds_read_b128 v[176:179], v6 offset:32768
  ds_read_b64_tr_b16 v[32:33], v10 offset:49152
  ds_read_b64_tr_b16 v[34:35], v10 offset:49664
  s_waitcnt lgkmcnt(8)
  v_mfma_f32_32x32x16_bf16 v[64:79], v[84:87], v[168:171], v[64:79]
  s_add_u32 s59, s58, s100
  s_lshl2_add_u32 s86, s50, s59
  s_lshl_b32 s86, s86, 10
  s_add_u32 s86, s86, 6291456
  s_sub_u32 s85, s86, 4096
  ds_read_b64_tr_b16 v[36:37], v10 offset:57344
  ds_read_b64_tr_b16 v[38:39], v10 offset:57856
  s_waitcnt lgkmcnt(7)
  v_mfma_f32_32x32x16_bf16 v[48:63], v[88:91], v[172:175], v[48:63]
  s_cmp_eq_u32 s96, 1
  s_cselect_b32 s85, s85, s54
  s_and_b32 s100, s47, 1
  s_lshl1_add_u32 s58, s100, s58
  s_lshl2_add_u32 s87, s51, s58
  s_lshl_b32 s87, s87, 10
  s_add_u32 s87, s87, 6291456
  ds_read_b128 v[180:183], v7 offset:32768
  ds_read_b64_tr_b16 v[40:41], v11 offset:49152
  ds_read_b64_tr_b16 v[42:43], v11 offset:49664
  s_add_u32 m0, s98, 24576
  s_mul_i32 s99, s81, 5
  s_add_u32 s99, s99, s80
  buffer_load_dwordx4 v18, s[12:15], s99 offen lds
  s_waitcnt lgkmcnt(8)
  v_mfma_f32_32x32x16_bf16 v[64:79], v[92:95], v[172:175], v[64:79]
  s_mov_b32 s101, 0x05040100
  s_mov_b32 s90, 0x3eb8aa3b
  s_cmp_lt_u32 s48, 7
  s_cselect_b32 s91, s90, 1.0
  s_cmp_lt_u32 s48, 8
  s_cselect_b32 s90, s90, 1.0
  ds_read_b64_tr_b16 v[44:45], v11 offset:57344
  ds_read_b64_tr_b16 v[46:47], v11 offset:57856
  s_waitcnt lgkmcnt(7)
  v_mfma_f32_32x32x16_bf16 v[48:63], v[32:35], v[176:179], v[48:63]
  ds_read_b128 v[184:187], v8 offset:32768
  ds_read_b64_tr_b16 v[80:81], v12 offset:49152
  ds_read_b64_tr_b16 v[82:83], v12 offset:49664
  s_cmp_lg_u32 s42, 0
  s_cbranch_scc1 L_ow_7
  global_load_dword v124, v126, s[40:41] sc1
L_ow_7:
  s_waitcnt lgkmcnt(8)
  v_mfma_f32_32x32x16_bf16 v[64:79], v[36:39], v[176:179], v[64:79]
  ds_read_b64_tr_b16 v[84:85], v12 offset:57344
  ds_read_b64_tr_b16 v[86:87], v12 offset:57856
  s_add_u32 m0, s97, 32768
  s_add_u32 s99, s78, 768
  buffer_load_dwordx4 v14, s[4:7], s99 offen lds
  v_mfma_f32_16x16x32_bf16 v[24:27], v[2:5], v[32:35], v[24:27]
  v_mfma_f32_16x16x32_bf16 v[28:31], v[2:5], v[36:39], v[28:31]
  ds_read_b128 v[188:191], v9 offset:32768
  ds_read_b64_tr_b16 v[88:89], v13 offset:49152
  ds_read_b64_tr_b16 v[90:91], v13 offset:49664
  s_add_u32 m0, s97, 33792
  s_add_u32 s99, s78, 768
  buffer_load_dwordx4 v15, s[4:7], s99 offen lds
  s_waitcnt lgkmcnt(10)
  v_mfma_f32_32x32x16_bf16 v[48:63], v[40:43], v[180:183], v[48:63]
  ds_read_b64_tr_b16 v[92:93], v13 offset:57344
  ds_read_b64_tr_b16 v[94:95], v13 offset:57856
  s_waitcnt lgkmcnt(10)
  v_mfma_f32_32x32x16_bf16 v[64:79], v[44:47], v[180:183], v[64:79]
  s_add_u32 m0, s98, 49152
  s_add_u32 s99, s79, 1179648
  buffer_load_dwordx4 v16, s[8:11], s99 offen lds
  s_waitcnt vmcnt(9)
  s_barrier
  s_waitcnt lgkmcnt(7)
  v_mfma_f32_32x32x16_bf16 v[48:63], v[80:83], v[184:187], v[48:63]
  v_add_u32 v6, 0x00010000, v6
  v_add_u32 v10, 0x00010000, v10
  ds_read_b128 v[192:195], v6 offset:0
  ds_read_b64_tr_b16 v[32:33], v10 offset:16384
  ds_read_b64_tr_b16 v[34:35], v10 offset:16896
  s_waitcnt lgkmcnt(8)
  v_mfma_f32_32x32x16_bf16 v[64:79], v[84:87], v[184:187], v[64:79]
  ds_read_b64_tr_b16 v[36:37], v10 offset:24576
  ds_read_b64_tr_b16 v[38:39], v10 offset:25088
  s_waitcnt lgkmcnt(7)
  v_mfma_f32_32x32x16_bf16 v[48:63], v[88:91], v[188:191], v[48:63]
  v_add_u32 v7, 0x00010000, v7
  v_add_u32 v11, 0x00010000, v11
  ds_read_b128 v[196:199], v7 offset:0
  ds_read_b64_tr_b16 v[40:41], v11 offset:16384
  ds_read_b64_tr_b16 v[42:43], v11 offset:16896
  s_add_u32 m0, s98, 57344
  s_mul_i32 s99, s81, 6
  s_add_u32 s99, s99, s80
  buffer_load_dwordx4 v18, s[12:15], s99 offen lds
  s_waitcnt lgkmcnt(8)
  v_mfma_f32_32x32x16_bf16 v[64:79], v[92:95], v[188:191], v[64:79]
  ds_read_b64_tr_b16 v[44:45], v11 offset:24576
  ds_read_b64_tr_b16 v[46:47], v11 offset:25088
  s_waitcnt lgkmcnt(7)
  v_mfma_f32_32x32x16_bf16 v[48:63], v[32:35], v[192:195], v[48:63]
  v_add_u32 v8, 0x00010000, v8
  v_add_u32 v12, 0x00010000, v12
  ds_read_b128 v[200:203], v8 offset:0
  ds_read_b64_tr_b16 v[80:81], v12 offset:16384
  ds_read_b64_tr_b16 v[82:83], v12 offset:16896
  s_waitcnt lgkmcnt(8)
  v_mfma_f32_32x32x16_bf16 v[64:79], v[36:39], v[192:195], v[64:79]
  ds_read_b64_tr_b16 v[84:85], v12 offset:24576
  ds_read_b64_tr_b16 v[86:87], v12 offset:25088
  s_add_u32 m0, s97, 65536
  s_add_u32 s99, s78, 896
  buffer_load_dwordx4 v14, s[4:7], s99 offen lds
  v_mfma_f32_16x16x32_bf16 v[24:27], v[2:5], v[32:35], v[24:27]
  v_mfma_f32_16x16x32_bf16 v[28:31], v[2:5], v[36:39], v[28:31]
  v_add_u32 v9, 0x00010000, v9
  v_add_u32 v13, 0x00010000, v13
  ds_read_b128 v[204:207], v9 offset:0
  ds_read_b64_tr_b16 v[88:89], v13 offset:16384
  ds_read_b64_tr_b16 v[90:91], v13 offset:16896
  s_add_u32 m0, s97, 66560
  s_add_u32 s99, s78, 896
  buffer_load_dwordx4 v15, s[4:7], s99 offen lds
  s_waitcnt lgkmcnt(10)
  v_mfma_f32_32x32x16_bf16 v[48:63], v[40:43], v[196:199], v[48:63]
  ds_read_b64_tr_b16 v[92:93], v13 offset:24576
  ds_read_b64_tr_b16 v[94:95], v13 offset:25088
  s_waitcnt lgkmcnt(10)
  v_mfma_f32_32x32x16_bf16 v[64:79], v[44:47], v[196:199], v[64:79]
  s_add_u32 m0, s98, 81920
  s_add_u32 s99, s79, 1376256
  buffer_load_dwordx4 v16, s[8:11], s99 offen lds
  s_cmp_lg_u32 s42, 0
  s_cbranch_scc1 L_ow_8
  s_waitcnt vmcnt(7)
  s_mov_b32 s59, 200000
  s_nop 4
L_gospin_9:
  v_readfirstlane_b32 s58, v124
  s_nop 0
  s_cmp_lg_u32 s58, 0
  s_nop 2
  s_cbranch_scc1 L_gook_10
  s_sub_u32 s59, s59, 1
  s_cmp_eq_u32 s59, 0
  s_cbranch_scc1 L_gook_10
    global_load_dword v124, v126, s[40:41] sc1
    s_waitcnt vmcnt(0)
  s_branch L_gospin_9
L_gook_10:
L_ow_8:
  s_waitcnt vmcnt(7)
  s_barrier
  s_waitcnt lgkmcnt(7)
  v_mfma_f32_32x32x16_bf16 v[48:63], v[80:83], v[200:203], v[48:63]
  v_add_u32 v6, 0xfffe0000, v6
  v_add_u32 v10, 0xfffe0000, v10
  ds_read_b128 v[208:211], v6 offset:0
  ds_read_b64_tr_b16 v[32:33], v10 offset:16384
  ds_read_b64_tr_b16 v[34:35], v10 offset:16896
  s_waitcnt lgkmcnt(8)
  v_mfma_f32_32x32x16_bf16 v[64:79], v[84:87], v[200:203], v[64:79]
  ds_read_b64_tr_b16 v[36:37], v10 offset:24576
  ds_read_b64_tr_b16 v[38:39], v10 offset:25088
  s_lshl_b32 s100, s55, 3
  s_add_u32 s100, s100, 15761408
  s_mov_b32 exec_lo, 0
  s_mov_b32 exec_hi, 0x80000000
  buffer_store_dwordx2 v[250:251], v126, s[20:23], s100 offen sc1
  s_mov_b64 exec, -1
  s_waitcnt lgkmcnt(7)
  v_mfma_f32_32x32x16_bf16 v[48:63], v[88:91], v[204:207], v[48:63]
  v_add_u32 v7, 0xfffe0000, v7
  v_add_u32 v11, 0xfffe0000, v11
  ds_read_b128 v[212:215], v7 offset:0
  ds_read_b64_tr_b16 v[40:41], v11 offset:16384
  ds_read_b64_tr_b16 v[42:43], v11 offset:16896
  s_add_u32 m0, s98, 90112
  s_mul_i32 s99, s81, 7
  s_add_u32 s99, s99, s80
  buffer_load_dwordx4 v18, s[12:15], s99 offen lds
  s_waitcnt lgkmcnt(8)
  v_mfma_f32_32x32x16_bf16 v[64:79], v[92:95], v[204:207], v[64:79]
  ds_read_b64_tr_b16 v[44:45], v11 offset:24576
  ds_read_b64_tr_b16 v[46:47], v11 offset:25088
  s_waitcnt lgkmcnt(7)
  v_mfma_f32_32x32x16_bf16 v[48:63], v[32:35], v[208:211], v[48:63]
  v_add_u32 v8, 0xfffe0000, v8
  v_add_u32 v12, 0xfffe0000, v12
  ds_read_b128 v[216:219], v8 offset:0
  ds_read_b64_tr_b16 v[80:81], v12 offset:16384
  ds_read_b64_tr_b16 v[82:83], v12 offset:16896
  s_waitcnt lgkmcnt(8)
  v_mfma_f32_32x32x16_bf16 v[64:79], v[36:39], v[208:211], v[64:79]
  ds_read_b64_tr_b16 v[84:85], v12 offset:24576
  ds_read_b64_tr_b16 v[86:87], v12 offset:25088
  s_add_u32 m0, s98, 98304
  s_add_u32 s99, s82, 0
  buffer_load_dwordx4 v17, s[16:19], s99 offen lds
  v_mfma_f32_16x16x32_bf16 v[24:27], v[2:5], v[32:35], v[24:27]
  v_mfma_f32_16x16x32_bf16 v[28:31], v[2:5], v[36:39], v[28:31]
  v_add_u32 v9, 0xfffe0000, v9
  v_add_u32 v13, 0xfffe0000, v13
  ds_read_b128 v[220:223], v9 offset:0
  ds_read_b64_tr_b16 v[88:89], v13 offset:16384
  ds_read_b64_tr_b16 v[90:91], v13 offset:16896
  s_add_u32 m0, s98, 106496
  s_add_u32 s99, s82, 229376
  buffer_load_dwordx4 v17, s[16:19], s99 offen lds
  s_waitcnt lgkmcnt(10)
  v_mfma_f32_32x32x16_bf16 v[48:63], v[40:43], v[212:215], v[48:63]
  ds_read_b64_tr_b16 v[92:93], v13 offset:24576
  ds_read_b64_tr_b16 v[94:95], v13 offset:25088
  s_waitcnt lgkmcnt(10)
  v_mfma_f32_32x32x16_bf16 v[64:79], v[44:47], v[212:215], v[64:79]
  s_add_u32 m0, s98, 114688
  s_add_u32 s99, s82, 458752
  buffer_load_dwordx4 v17, s[16:19], s99 offen lds
  s_waitcnt vmcnt(8)
  s_barrier
  s_waitcnt lgkmcnt(7)
  v_mfma_f32_32x32x16_bf16 v[48:63], v[80:83], v[216:219], v[48:63]
  ds_read_b128 v[224:227], v6 offset:32768
  ds_read_b64_tr_b16 v[32:33], v10 offset:49152
  ds_read_b64_tr_b16 v[34:35], v10 offset:49664
  s_waitcnt lgkmcnt(8)
  v_mfma_f32_32x32x16_bf16 v[64:79], v[84:87], v[216:219], v[64:79]
  ds_read_b64_tr_b16 v[36:37], v10 offset:57344
  ds_read_b64_tr_b16 v[38:39], v10 offset:57856
  s_waitcnt lgkmcnt(7)
  v_mfma_f32_32x32x16_bf16 v[48:63], v[88:91], v[220:223], v[48:63]
  ds_read_b128 v[228:231], v7 offset:32768
  ds_read_b64_tr_b16 v[40:41], v11 offset:49152
  ds_read_b64_tr_b16 v[42:43], v11 offset:49664
  s_add_u32 m0, s98, 122880
  s_add_u32 s99, s82, 688128
  buffer_load_dwordx4 v17, s[16:19], s99 offen lds
  s_waitcnt lgkmcnt(8)
  v_mfma_f32_32x32x16_bf16 v[64:79], v[92:95], v[220:223], v[64:79]
  ds_read_b64_tr_b16 v[44:45], v11 offset:57344
  ds_read_b64_tr_b16 v[46:47], v11 offset:57856
  s_waitcnt lgkmcnt(7)
  v_mfma_f32_32x32x16_bf16 v[48:63], v[32:35], v[224:227], v[48:63]
  ds_read_b128 v[232:235], v8 offset:32768
  ds_read_b64_tr_b16 v[80:81], v12 offset:49152
  ds_read_b64_tr_b16 v[82:83], v12 offset:49664
  s_waitcnt lgkmcnt(8)
  v_mfma_f32_32x32x16_bf16 v[64:79], v[36:39], v[224:227], v[64:79]
  ds_read_b64_tr_b16 v[84:85], v12 offset:57344
  ds_read_b64_tr_b16 v[86:87], v12 offset:57856
  s_add_u32 m0, s98, 131072
  s_add_u32 s99, s82, 917504
  buffer_load_dwordx4 v17, s[16:19], s99 offen lds
  v_mfma_f32_16x16x32_bf16 v[24:27], v[2:5], v[32:35], v[24:27]
  v_mfma_f32_16x16x32_bf16 v[28:31], v[2:5], v[36:39], v[28:31]
  ds_read_b128 v[236:239], v9 offset:32768
  ds_read_b64_tr_b16 v[88:89], v13 offset:49152
  ds_read_b64_tr_b16 v[90:91], v13 offset:49664
  s_add_u32 m0, s98, 139264
  s_add_u32 s99, s82, 1146880
  buffer_load_dwordx4 v17, s[16:19], s99 offen lds
  s_waitcnt lgkmcnt(10)
  v_mfma_f32_32x32x16_bf16 v[48:63], v[40:43], v[228:231], v[48:63]
  ds_read_b64_tr_b16 v[92:93], v13 offset:57344
  ds_read_b64_tr_b16 v[94:95], v13 offset:57856
  s_waitcnt lgkmcnt(10)
  v_mfma_f32_32x32x16_bf16 v[64:79], v[44:47], v[228:231], v[64:79]
  s_add_u32 m0, s98, 147456
  s_add_u32 s99, s82, 1376256
  buffer_load_dwordx4 v17, s[16:19], s99 offen lds
  s_waitcnt vmcnt(7)
  s_barrier
  s_waitcnt lgkmcnt(7)
  v_mfma_f32_32x32x16_bf16 v[48:63], v[80:83], v[232:235], v[48:63]
  v_add_u32 v6, 0x00010000, v6
  v_add_u32 v10, 0x00010000, v10
  ds_read_b128 v[240:243], v6 offset:0
  ds_read_b64_tr_b16 v[32:33], v10 offset:16384
  ds_read_b64_tr_b16 v[34:35], v10 offset:16896
  s_waitcnt lgkmcnt(8)
  v_mfma_f32_32x32x16_bf16 v[64:79], v[84:87], v[232:235], v[64:79]
  ds_read_b64_tr_b16 v[36:37], v10 offset:24576
  ds_read_b64_tr_b16 v[38:39], v10 offset:25088
  s_waitcnt lgkmcnt(7)
  v_mfma_f32_32x32x16_bf16 v[48:63], v[88:91], v[236:239], v[48:63]
  v_add_u32 v7, 0x00010000, v7
  v_add_u32 v11, 0x00010000, v11
  ds_read_b128 v[244:247], v7 offset:0
  ds_read_b64_tr_b16 v[40:41], v11 offset:16384
  ds_read_b64_tr_b16 v[42:43], v11 offset:16896
  s_add_u32 m0, s98, 155648
  s_add_u32 s99, s82, 1605632
  buffer_load_dwordx4 v17, s[16:19], s99 offen lds
  s_waitcnt lgkmcnt(8)
  v_mfma_f32_32x32x16_bf16 v[64:79], v[92:95], v[236:239], v[64:79]
  ds_read_b64_tr_b16 v[44:45], v11 offset:24576
  ds_read_b64_tr_b16 v[46:47], v11 offset:25088
  s_waitcnt lgkmcnt(7)
  v_mfma_f32_32x32x16_bf16 v[48:63], v[32:35], v[240:243], v[48:63]
  v_add_u32 v8, 0x00010000, v8
  v_add_u32 v12, 0x00010000, v12
  ds_read_b128 v[248:251], v8 offset:0
  ds_read_b64_tr_b16 v[80:81], v12 offset:16384
  ds_read_b64_tr_b16 v[82:83], v12 offset:16896
  s_mov_b32 s54, s57
  buffer_load_dwordx2 v[20:21], v122, s[20:23], s57 offen sc1
  s_waitcnt lgkmcnt(8)
  v_mfma_f32_32x32x16_bf16 v[64:79], v[36:39], v[240:243], v[64:79]
  ds_read_b64_tr_b16 v[84:85], v12 offset:24576
  ds_read_b64_tr_b16 v[86:87], v12 offset:25088
  s_lshl_b32 s99, s42, 12
  s_add_u32 m0, s99, 0
  s_add_u32 s99, s83, 0
  buffer_load_dwordx4 v19, s[16:19], s99 offen lds
  v_mfma_f32_16x16x32_bf16 v[24:27], v[2:5], v[32:35], v[24:27]
  v_mfma_f32_16x16x32_bf16 v[28:31], v[2:5], v[36:39], v[28:31]
  v_add_u32 v9, 0x00010000, v9
  v_add_u32 v13, 0x00010000, v13
  ds_read_b128 v[252:255], v9 offset:0
  ds_read_b64_tr_b16 v[88:89], v13 offset:16384
  ds_read_b64_tr_b16 v[90:91], v13 offset:16896
  s_lshl_b32 s99, s42, 12
  s_add_u32 m0, s99, 1024
  s_add_u32 s99, s83, 57344
  buffer_load_dwordx4 v19, s[16:19], s99 offen lds
  s_waitcnt lgkmcnt(10)
  v_mfma_f32_32x32x16_bf16 v[48:63], v[40:43], v[244:247], v[48:63]
  ds_read_b64_tr_b16 v[92:93], v13 offset:24576
  ds_read_b64_tr_b16 v[94:95], v13 offset:25088
  s_waitcnt lgkmcnt(10)
  v_mfma_f32_32x32x16_bf16 v[64:79], v[44:47], v[244:247], v[64:79]
  s_lshl_b32 s99, s42, 12
  s_add_u32 m0, s99, 2048
  s_add_u32 s99, s83, 114688
  buffer_load_dwordx4 v19, s[16:19], s99 offen lds
  s_waitcnt lgkmcnt(0)
  s_waitcnt vmcnt(8)
  s_barrier
  v_mfma_f32_32x32x16_bf16 v[48:63], v[80:83], v[248:251], v[48:63]
  v_add_u32 v10, 0x00008000, v10
  ds_read_b64_tr_b16 v[32:33], v10 offset:0
  ds_read_b64_tr_b16 v[34:35], v10 offset:512
  v_mfma_f32_32x32x16_bf16 v[64:79], v[84:87], v[248:251], v[64:79]
  v_mfma_f32_32x32x16_bf16 v[48:63], v[88:91], v[252:255], v[48:63]
  v_add_u32 v11, 0x00008000, v11
  ds_read_b64_tr_b16 v[36:37], v11 offset:0
  ds_read_b64_tr_b16 v[38:39], v11 offset:512
  s_lshl_b32 s99, s42, 12
  s_add_u32 m0, s99, 3072
  s_add_u32 s99, s83, 172032
  buffer_load_dwordx4 v19, s[16:19], s99 offen lds
  v_mfma_f32_32x32x16_bf16 v[64:79], v[92:95], v[252:255], v[64:79]
  v_add_u32 v12, 0x00008000, v12
  v_add_u32 v13, 0x00008000, v13
  ds_write_b32 v123, v24
  ds_write_b32 v123, v28 offset:1024
  s_cmp_eq_u32 s96, 1
  s_nop 6
  s_cbranch_scc1 L_passB_h_11
  s_waitcnt lgkmcnt(4)
  v_mfma_f32_32x32x16_bf16 v[80:95], v[32:35], v[128:131], 0
  ds_read_b64_tr_b16 v[40:41], v12 offset:0
  ds_read_b64_tr_b16 v[42:43], v12 offset:512
  v_mfma_f32_16x16x32_bf16 v[24:27], v[2:5], v[32:35], 0
  s_waitcnt lgkmcnt(0)
  s_barrier
  v_mfma_f32_32x32x16_bf16 v[80:95], v[36:39], v[132:135], v[80:95]
  ds_read_b64_tr_b16 v[44:45], v13 offset:0
  ds_read_b64_tr_b16 v[46:47], v13 offset:512
  s_lshl_b32 s94, s88, 2
  s_lshr_b32 s99, s89, 3
  s_add_u32 s94, s94, s99
  s_and_b32 s95, s89, 7
  s_lshr_b32 s99, s42, 2
  s_lshl_b32 s100, s95, 7
  s_mul_i32 s60, s99, 917504
  s_add_u32 s60, s60, s100
  s_mul_i32 s61, s99, 262144
  s_add_u32 s61, s61, s100
  s_lshr_b32 s100, s42, 1
  s_and_b32 s100, s100, 1
  s_lshl_b32 s62, s94, 1
  s_add_u32 s100, s100, s62
  s_and_b32 s64, s42, 1
  s_lshl_b32 s64, s64, 1
  s_mul_i32 s62, s100, 112
  s_add_u32 s62, s62, s64
  s_mul_i32 s63, s99, 56
  s_add_u32 s62, s62, s63
  s_lshl_b32 s62, s62, 10
  s_add_u32 s62, s62, 6291456
  s_lshl_b32 s63, s100, 5
  s_add_u32 s63, s63, s64
  s_lshl_b32 s99, s99, 4
  s_add_u32 s63, s63, s99
  s_lshl_b32 s63, s63, 10
  s_add_u32 s63, s63, 13631488
  s_lshl_b32 s64, s42, 11
  s_mul_i32 s70, s95, 7
  s_lshr_b32 s70, s70, 2
  s_lshr_b32 s99, s89, 3
  s_mul_i32 s99, s99, 7
  s_lshr_b32 s99, s99, 1
  s_add_u32 s70, s70, s99
  s_sub_u32 s99, s70, 14
  s_cmp_ge_u32 s70, 14
  s_cselect_b32 s70, s99, s70
  s_lshl_b32 s99, s70, 16
  s_add_u32 s60, s60, s99
  s_lshl_b32 s99, s70, 12
  s_add_u32 s62, s62, s99
  v_lshrrev_b32 v110, 3, v1
  v_and_b32 v111, 7, v1
  v_lshrrev_b32 v112, 1, v110
  v_and_b32 v112, 1, v112
  v_lshlrev_b32 v112, 2, v112
  v_xor_b32 v111, v111, v112
  v_lshlrev_b32 v111, 4, v111
  s_and_b32 s99, s42, 3
  s_lshl_b32 s99, s99, 4
  v_add_u32 v110, s99, v110
  v_lshl_add_u32 v18, v110, 10, v111
  s_waitcnt vmcnt(4)
  v_cmp_eq_u32 vcc, 0xbf800000, v21
  s_nop 0
  s_cbranch_vccnz L_rspin_13
L_rok_14:
  v_add_f32 v112, 0x3727c5ac, v21
  v_rsq_f32 v112, v112
  s_nop 0
  v_mul_f32 v113, v21, v112
  v_mul_f32 v113, v113, v112
  v_add_f32 v113, 0x3727c5ac, v113
  v_rsq_f32 v113, v113
  v_mfma_f32_32x32x16_bf16 v[80:95], v[40:43], v[136:139], v[80:95]
  ds_read_b64_tr_b16 v[32:33], v10 offset:8192
  ds_read_b64_tr_b16 v[34:35], v10 offset:8704
  v_mul_f32 v113, v113, v112
  v_sub_f32 v110, 0, v20
  v_mul_f32 v104, s90, v112
  v_mul_f32 v105, s91, v112
  v_rcp_f32 v114, v113
  v_mul_f32 v22, 0xc0135761, v113
  s_waitcnt lgkmcnt(2)
  v_mfma_f32_32x32x16_bf16 v[80:95], v[44:47], v[140:143], v[80:95]
  ds_read_b64_tr_b16 v[36:37], v11 offset:8192
  ds_read_b64_tr_b16 v[38:39], v11 offset:8704
  v_mul_f32 v111, v113, v113
  v_mul_f32 v111, v111, v113
  v_mul_f32 v23, 0xbdd2d3e8, v111
  v_cvt_pk_bf16_f32 v115, v110, v110
  v_cvt_pk_bf16_f32 v116, v114, v114
  v_and_b32 v117, s74, v115
  v_and_b32 v116, s74, v116
  s_waitcnt lgkmcnt(2)
  v_mfma_f32_32x32x16_bf16 v[80:95], v[32:35], v[144:147], v[80:95]
  ds_read_b64_tr_b16 v[40:41], v12 offset:8192
  ds_read_b64_tr_b16 v[42:43], v12 offset:8704
  v_sub_f32 v117, v110, v117
  v_sub_f32 v116, v114, v116
  v_cvt_pk_bf16_f32 v117, v117, v114
  v_cvt_pk_bf16_f32 v116, v116, 0
  v_cndmask_b32 v96, 0, v115, s[76:77]
  v_cndmask_b32 v97, 0, v117, s[76:77]
  v_cndmask_b32 v98, 0, v116, s[76:77]
  v_mov_b32 v99, 0
  v_mfma_f32_16x16x32_bf16 v[24:27], v[2:5], v[32:35], v[24:27]
  v_mov_b32 v103, 0
  ds_read_b128 v[118:121], v125 offset:0
  s_waitcnt lgkmcnt(0)
  v_add_f32 v118, v118, v119
  v_add_f32 v120, v120, v121
  v_add_f32 v118, v118, v120
  v_cvt_pk_bf16_f32 v119, v118, v118
  v_and_b32 v120, s74, v119
  v_sub_f32 v120, v118, v120
  v_mfma_f32_32x32x16_bf16 v[80:95], v[36:39], v[148:151], v[80:95]
  ds_read_b64_tr_b16 v[44:45], v13 offset:8192
  ds_read_b64_tr_b16 v[46:47], v13 offset:8704
  s_cmp_ge_u32 s70, 14
  s_cselect_b32 s71, 917504, 0
  s_sub_u32 s71, s60, s71
  s_add_u32 s71, s71, 0
  s_add_u32 m0, s64, 32768
  s_mov_b32 s57, s71
  buffer_load_dwordx4 v18, s[24:27], s57 offen lds
  v_cvt_pk_bf16_f32 v100, v118, v120
  v_and_b32 v101, 0xffff, v119
  v_mov_b32 v102, 0
  s_nop 1
  v_mfma_f32_32x32x16_bf16 v[48:63], v[100:103], v[96:99], v[48:63]
  ds_read_b128 v[118:121], v125 offset:1024
  s_waitcnt lgkmcnt(0)
  v_add_f32 v118, v118, v119
  v_mfma_f32_32x32x16_bf16 v[80:95], v[40:43], v[152:155], v[80:95]
  ds_read_b64_tr_b16 v[32:33], v10 offset:16384
  ds_read_b64_tr_b16 v[34:35], v10 offset:16896
  v_add_f32 v120, v120, v121
  v_add_f32 v118, v118, v120
  v_cvt_pk_bf16_f32 v119, v118, v118
  v_and_b32 v120, s74, v119
  v_sub_f32 v120, v118, v120
  v_cvt_pk_bf16_f32 v100, v118, v120
  v_and_b32 v101, 0xffff, v119
  v_mov_b32 v102, 0
  v_mfma_f32_32x32x16_bf16 v[80:95], v[44:47], v[156:159], v[80:95]
  ds_read_b64_tr_b16 v[36:37], v11 offset:16384
  ds_read_b64_tr_b16 v[38:39], v11 offset:16896
  v_mfma_f32_32x32x16_bf16 v[64:79], v[100:103], v[96:99], v[64:79]
  v_mul_f32 v48, v104, v48
  v_mul_f32 v49, v104, v49
  v_mul_f32 v50, v104, v50
  v_mul_f32 v51, v104, v51
  v_mul_f32 v52, v104, v52
  s_waitcnt lgkmcnt(2)
  v_mfma_f32_32x32x16_bf16 v[80:95], v[32:35], v[160:163], v[80:95]
  ds_read_b64_tr_b16 v[40:41], v12 offset:16384
  ds_read_b64_tr_b16 v[42:43], v12 offset:16896
  v_mul_f32 v53, v104, v53
  v_mul_f32 v54, v104, v54
  v_mul_f32 v55, v104, v55
  v_cvt_pk_bf16_f32 v48, v48, v49
  v_cvt_pk_bf16_f32 v49, v50, v51
  v_cvt_pk_bf16_f32 v50, v52, v53
  v_cvt_pk_bf16_f32 v51, v54, v55
  buffer_store_dwordx4 v[48:51], v127, s[20:23], s84 offen sc1
  v_mfma_f32_16x16x32_bf16 v[24:27], v[2:5], v[32:35], v[24:27]
  s_add_u32 m0, s64, 33792
  s_add_u32 s57, s71, 8192
  buffer_load_dwordx4 v18, s[24:27], s57 offen lds
  v_mul_f32 v56, v104, v56
  v_mul_f32 v57, v104, v57
  v_mul_f32 v58, v104, v58
  v_mul_f32 v59, v104, v59
  v_mul_f32 v60, v104, v60
  v_mul_f32 v61, v104, v61
  v_mul_f32 v62, v104, v62
  s_waitcnt lgkmcnt(2)
  v_mfma_f32_32x32x16_bf16 v[80:95], v[36:39], v[164:167], v[80:95]
  ds_read_b64_tr_b16 v[44:45], v13 offset:16384
  ds_read_b64_tr_b16 v[46:47], v13 offset:16896
  v_mul_f32 v63, v104, v63
  v_cvt_pk_bf16_f32 v52, v56, v57
  v_cvt_pk_bf16_f32 v53, v58, v59
  v_cvt_pk_bf16_f32 v54, v60, v61
  v_cvt_pk_bf16_f32 v55, v62, v63
  buffer_store_dwordx4 v[52:55], v127, s[20:23], s52 offen sc1
  v_mul_f32 v64, v105, v64
  v_mul_f32 v65, v105, v65
  v_mul_f32 v66, v105, v66
  s_waitcnt lgkmcnt(2)
  v_mfma_f32_32x32x16_bf16 v[80:95], v[40:43], v[168:171], v[80:95]
  ds_read_b64_tr_b16 v[32:33], v10 offset:24576
  ds_read_b64_tr_b16 v[34:35], v10 offset:25088
  v_mul_f32 v67, v105, v67
  v_mul_f32 v68, v105, v68
  v_mul_f32 v69, v105, v69
  v_mul_f32 v70, v105, v70
  v_mul_f32 v71, v105, v71
  v_cvt_pk_bf16_f32 v64, v64, v65
  v_cvt_pk_bf16_f32 v65, v66, v67
  s_waitcnt lgkmcnt(2)
  v_mfma_f32_32x32x16_bf16 v[80:95], v[44:47], v[172:175], v[80:95]
  ds_read_b64_tr_b16 v[36:37], v11 offset:24576
  ds_read_b64_tr_b16 v[38:39], v11 offset:25088
  v_cvt_pk_bf16_f32 v66, v68, v69
  v_cvt_pk_bf16_f32 v67, v70, v71
  buffer_store_dwordx4 v[64:67], v127, s[20:23], s85 offen sc1
  v_mul_f32 v72, v105, v72
  v_mul_f32 v73, v105, v73
  v_mul_f32 v74, v105, v74
  v_mul_f32 v75, v105, v75
  v_mul_f32 v76, v105, v76
  s_waitcnt lgkmcnt(2)
  v_mfma_f32_32x32x16_bf16 v[80:95], v[32:35], v[176:179], v[80:95]
  ds_read_b64_tr_b16 v[40:41], v12 offset:24576
  ds_read_b64_tr_b16 v[42:43], v12 offset:25088
  s_cmp_ge_u32 s70, 13
  s_cselect_b32 s71, 917504, 0
  s_sub_u32 s71, s60, s71
  s_add_u32 s71, s71, 65536
  s_add_u32 m0, s64, 49152
  s_mov_b32 s57, s71
  buffer_load_dwordx4 v18, s[24:27], s57 offen lds
  v_mul_f32 v77, v105, v77
  v_mul_f32 v78, v105, v78
  v_mul_f32 v79, v105, v79
  v_cvt_pk_bf16_f32 v68, v72, v73
  v_cvt_pk_bf16_f32 v69, v74, v75
  v_cvt_pk_bf16_f32 v70, v76, v77
  v_cvt_pk_bf16_f32 v71, v78, v79
  buffer_store_dwordx4 v[68:71], v127, s[20:23], s53 offen sc1
  v_mfma_f32_16x16x32_bf16 v[24:27], v[2:5], v[32:35], v[24:27]
  s_waitcnt vmcnt(7)
  s_barrier
  s_waitcnt lgkmcnt(2)
  v_mfma_f32_32x32x16_bf16 v[80:95], v[36:39], v[180:183], v[80:95]
  ds_read_b64_tr_b16 v[44:45], v13 offset:24576
  ds_read_b64_tr_b16 v[46:47], v13 offset:25088
  s_waitcnt lgkmcnt(2)
  v_mfma_f32_32x32x16_bf16 v[80:95], v[40:43], v[184:187], v[80:95]
  ds_read_b64_tr_b16 v[32:33], v10 offset:32768
  ds_read_b64_tr_b16 v[34:35], v10 offset:33280
  s_waitcnt lgkmcnt(2)
  v_mfma_f32_32x32x16_bf16 v[80:95], v[44:47], v[188:191], v[80:95]
  ds_read_b64_tr_b16 v[36:37], v10 offset:40960
  ds_read_b64_tr_b16 v[38:39], v10 offset:41472
  s_add_u32 m0, s64, 50176
  s_add_u32 s57, s71, 8192
  buffer_load_dwordx4 v18, s[24:27], s57 offen lds
  s_waitcnt lgkmcnt(2)
  v_mfma_f32_32x32x16_bf16 v[80:95], v[32:35], v[192:195], v[80:95]
  ds_read_b64_tr_b16 v[40:41], v10 offset:49152
  ds_read_b64_tr_b16 v[42:43], v10 offset:49664
  v_mfma_f32_16x16x32_bf16 v[24:27], v[2:5], v[32:35], v[24:27]
  s_waitcnt lgkmcnt(2)
  v_mfma_f32_32x32x16_bf16 v[80:95], v[36:39], v[208:211], v[80:95]
  ds_read_b64_tr_b16 v[44:45], v10 offset:57344
  ds_read_b64_tr_b16 v[46:47], v10 offset:57856
  v_mfma_f32_16x16x32_bf16 v[24:27], v[2:5], v[36:39], v[24:27]
  s_cmp_ge_u32 s70, 12
  s_cselect_b32 s71, 917504, 0
  s_sub_u32 s71, s60, s71
  s_add_u32 s71, s71, 131072
  s_add_u32 m0, s64, 65536
  s_mov_b32 s57, s71
  buffer_load_dwordx4 v18, s[24:27], s57 offen lds
  s_waitcnt lgkmcnt(2)
  v_mfma_f32_32x32x16_bf16 v[80:95], v[40:43], v[224:227], v[80:95]
  ds_read_b64_tr_b16 v[32:33], v11 offset:32768
  ds_read_b64_tr_b16 v[34:35], v11 offset:33280
  v_mfma_f32_16x16x32_bf16 v[24:27], v[2:5], v[40:43], v[24:27]
  s_waitcnt lgkmcnt(2)
  v_mfma_f32_32x32x16_bf16 v[80:95], v[44:47], v[240:243], v[80:95]
  ds_read_b64_tr_b16 v[36:37], v12 offset:32768
  ds_read_b64_tr_b16 v[38:39], v12 offset:33280
  v_mfma_f32_16x16x32_bf16 v[24:27], v[2:5], v[44:47], v[24:27]
  s_add_u32 m0, s64, 66560
  s_add_u32 s57, s71, 8192
  buffer_load_dwordx4 v18, s[24:27], s57 offen lds
  s_waitcnt lgkmcnt(2)
  v_mfma_f32_32x32x16_bf16 v[80:95], v[32:35], v[196:199], v[80:95]
  ds_read_b64_tr_b16 v[40:41], v13 offset:32768
  ds_read_b64_tr_b16 v[42:43], v13 offset:33280
  s_nop 0
  ds_write_b32 v123, v24 offset:2048
  s_waitcnt lgkmcnt(3)
  v_mfma_f32_32x32x16_bf16 v[80:95], v[36:39], v[200:203], v[80:95]
  ds_read_b64_tr_b16 v[44:45], v11 offset:40960
  ds_read_b64_tr_b16 v[46:47], v11 offset:41472
  s_waitcnt lgkmcnt(3)
  v_mfma_f32_32x32x16_bf16 v[80:95], v[40:43], v[204:207], v[80:95]
  ds_read_b64_tr_b16 v[32:33], v12 offset:40960
  ds_read_b64_tr_b16 v[34:35], v12 offset:41472
  s_xor_b32 s99, s43, s44
  s_lshl_b32 s99, s99, 10
  v_and_b32 v6, 3, v1
  v_lshlrev_b32 v6, 3, v6
  v_bfe_u32 v7, v1, 4, 1
  v_lshl_or_b32 v6, v7, 5, v6
  v_bfe_u32 v7, v1, 2, 2
  v_lshl_or_b32 v6, v7, 6, v6
  v_lshrrev_b32 v7, 5, v1
  v_lshl_or_b32 v6, v7, 9, v6
  v_or_b32 v6, s99, v6
  v_xor_b32 v7, 0x00000400, v6
  v_xor_b32 v8, 0x00000800, v6
  v_xor_b32 v9, 0x00000c00, v6
  s_waitcnt lgkmcnt(2)
  v_mfma_f32_32x32x16_bf16 v[80:95], v[44:47], v[212:215], v[80:95]
  ds_read_b64_tr_b16 v[36:37], v13 offset:40960
  ds_read_b64_tr_b16 v[38:39], v13 offset:41472
  s_waitcnt lgkmcnt(2)
  v_mfma_f32_32x32x16_bf16 v[80:95], v[32:35], v[216:219], v[80:95]
  ds_read_b64_tr_b16 v[40:41], v11 offset:49152
  ds_read_b64_tr_b16 v[42:43], v11 offset:49664
  s_waitcnt lgkmcnt(2)
  v_mfma_f32_32x32x16_bf16 v[80:95], v[36:39], v[220:223], v[80:95]
  ds_read_b64_tr_b16 v[44:45], v12 offset:49152
  ds_read_b64_tr_b16 v[46:47], v12 offset:49664
  s_waitcnt lgkmcnt(0)
  s_barrier
  v_mfma_f32_32x32x16_bf16 v[80:95], v[40:43], v[228:231], v[80:95]
  ds_read_b64_tr_b16 v[32:33], v13 offset:49152
  ds_read_b64_tr_b16 v[34:35], v13 offset:49664
  v_mfma_f32_32x32x16_bf16 v[80:95], v[44:47], v[232:235], v[80:95]
  ds_read_b64_tr_b16 v[36:37], v11 offset:57344
  ds_read_b64_tr_b16 v[38:39], v11 offset:57856
  s_lshl2_add_u32 s99, s45, s43
  s_lshl_b32 s100, s44, 6
  s_add_u32 s99, s99, s100
  s_lshl_b32 s100, s48, 7
  s_add_u32 s99, s99, s100
  s_lshl_b32 s99, s99, 2
  s_add_u32 s99, s99, 15728640
  v_lshlrev_b32 v14, 9, v1
  v_mov_b32 v15, 1
  s_waitcnt vmcnt(3)
  s_mov_b64 exec, 0x3
  buffer_store_dword v15, v14, s[20:23], s99 offen sc1
  s_mov_b64 exec, -1
  ds_read_b128 v[118:121], v125 offset:2048
  s_waitcnt lgkmcnt(0)
  v_add_f32 v118, v118, v119
  v_mfma_f32_32x32x16_bf16 v[80:95], v[32:35], v[236:239], v[80:95]
  ds_read_b64_tr_b16 v[40:41], v12 offset:57344
  ds_read_b64_tr_b16 v[42:43], v12 offset:57856
  v_add_f32 v120, v120, v121
  v_add_f32 v118, v118, v120
  v_cvt_pk_bf16_f32 v119, v118, v118
  v_mfma_f32_32x32x16_bf16 v[80:95], v[36:39], v[244:247], v[80:95]
  ds_read_b64_tr_b16 v[44:45], v13 offset:57344
  ds_read_b64_tr_b16 v[46:47], v13 offset:57856
  v_and_b32 v120, s74, v119
  v_sub_f32 v120, v118, v120
  s_waitcnt lgkmcnt(2)
  v_mfma_f32_32x32x16_bf16 v[80:95], v[40:43], v[248:251], v[80:95]
  v_cvt_pk_bf16_f32 v100, v118, v120
  v_perm_b32 v101, v108, v119, s101
  v_mov_b32 v102, v108
  s_waitcnt lgkmcnt(0)
  v_mfma_f32_32x32x16_bf16 v[80:95], v[44:47], v[252:255], v[80:95]
  v_mfma_f32_32x32x16_bf16 v[80:95], v[100:103], v[96:99], v[80:95]
  s_nop 11
  s_branch L_passB_done_12
L_passB_h_11:
  s_waitcnt lgkmcnt(4)
  v_mfma_f32_32x32x16_bf16 v[80:95], v[32:35], v[128:131], 0
  ds_read_b64_tr_b16 v[40:41], v12 offset:0
  ds_read_b64_tr_b16 v[42:43], v12 offset:512
  v_mfma_f32_16x16x32_bf16 v[24:27], v[2:5], v[32:35], 0
  s_waitcnt lgkmcnt(0)
  s_barrier
  v_mfma_f32_32x32x16_bf16 v[80:95], v[36:39], v[132:135], v[80:95]
  ds_read_b64_tr_b16 v[44:45], v13 offset:0
  ds_read_b64_tr_b16 v[46:47], v13 offset:512
  s_lshl_b32 s94, s88, 2
  s_lshr_b32 s99, s89, 3
  s_add_u32 s94, s94, s99
  s_and_b32 s95, s89, 7
  s_lshr_b32 s99, s42, 2
  s_lshl_b32 s100, s95, 7
  s_mul_i32 s60, s99, 917504
  s_add_u32 s60, s60, s100
  s_mul_i32 s61, s99, 262144
  s_add_u32 s61, s61, s100
  s_lshr_b32 s100, s42, 1
  s_and_b32 s100, s100, 1
  s_lshl_b32 s62, s94, 1
  s_add_u32 s100, s100, s62
  s_and_b32 s64, s42, 1
  s_lshl_b32 s64, s64, 1
  s_mul_i32 s62, s100, 112
  s_add_u32 s62, s62, s64
  s_mul_i32 s63, s99, 56
  s_add_u32 s62, s62, s63
  s_lshl_b32 s62, s62, 10
  s_add_u32 s62, s62, 6291456
  s_lshl_b32 s63, s100, 5
  s_add_u32 s63, s63, s64
  s_lshl_b32 s99, s99, 4
  s_add_u32 s63, s63, s99
  s_lshl_b32 s63, s63, 10
  s_add_u32 s63, s63, 13631488
  s_lshl_b32 s64, s42, 11
  s_mul_i32 s70, s95, 7
  s_lshr_b32 s70, s70, 2
  s_lshr_b32 s99, s89, 3
  s_mul_i32 s99, s99, 7
  s_lshr_b32 s99, s99, 1
  s_add_u32 s70, s70, s99
  s_sub_u32 s99, s70, 14
  s_cmp_ge_u32 s70, 14
  s_cselect_b32 s70, s99, s70
  s_lshl_b32 s99, s70, 16
  s_add_u32 s60, s60, s99
  s_lshl_b32 s99, s70, 12
  s_add_u32 s62, s62, s99
  v_lshrrev_b32 v110, 3, v1
  v_and_b32 v111, 7, v1
  v_lshrrev_b32 v112, 1, v110
  v_and_b32 v112, 1, v112
  v_lshlrev_b32 v112, 2, v112
  v_xor_b32 v111, v111, v112
  v_lshlrev_b32 v111, 4, v111
  s_and_b32 s99, s42, 3
  s_lshl_b32 s99, s99, 4
  v_add_u32 v110, s99, v110
  v_lshl_add_u32 v18, v110, 10, v111
  s_waitcnt vmcnt(4)
  v_cmp_eq_u32 vcc, 0xbf800000, v21
  s_nop 0
  s_cbranch_vccnz L_rspin_15
L_rok_16:
  v_add_f32 v112, 0x3727c5ac, v21
  v_rsq_f32 v112, v112
  s_nop 0
  v_mul_f32 v113, v21, v112
  v_mul_f32 v113, v113, v112
  v_add_f32 v113, 0x3727c5ac, v113
  v_rsq_f32 v113, v113
  v_mfma_f32_32x32x16_bf16 v[80:95], v[40:43], v[136:139], v[80:95]
  ds_read_b64_tr_b16 v[32:33], v10 offset:8192
  ds_read_b64_tr_b16 v[34:35], v10 offset:8704
  v_mul_f32 v113, v113, v112
  v_sub_f32 v110, 0, v20
  v_mul_f32 v104, s90, v112
  v_mul_f32 v105, s91, v112
  v_rcp_f32 v114, v113
  s_waitcnt lgkmcnt(2)
  v_mfma_f32_32x32x16_bf16 v[80:95], v[44:47], v[140:143], v[80:95]
  ds_read_b64_tr_b16 v[36:37], v11 offset:8192
  ds_read_b64_tr_b16 v[38:39], v11 offset:8704
  v_mul_f32 v22, 0xc0135761, v113
  v_mul_f32 v111, v113, v113
  v_mul_f32 v111, v111, v113
  v_mul_f32 v23, 0xbdd2d3e8, v111
  v_cvt_pk_bf16_f32 v115, v110, v110
  v_cvt_pk_bf16_f32 v116, v114, v114
  v_and_b32 v117, s74, v115
  v_and_b32 v116, s74, v116
  s_waitcnt lgkmcnt(2)
  v_mfma_f32_32x32x16_bf16 v[80:95], v[32:35], v[144:147], v[80:95]
  ds_read_b64_tr_b16 v[40:41], v12 offset:8192
  ds_read_b64_tr_b16 v[42:43], v12 offset:8704
  v_sub_f32 v117, v110, v117
  v_sub_f32 v116, v114, v116
  v_cvt_pk_bf16_f32 v117, v117, v114
  v_cvt_pk_bf16_f32 v116, v116, 0
  v_cndmask_b32 v96, 0, v115, s[76:77]
  v_cndmask_b32 v97, 0, v117, s[76:77]
  v_cndmask_b32 v98, 0, v116, s[76:77]
  v_mfma_f32_16x16x32_bf16 v[24:27], v[2:5], v[32:35], v[24:27]
  v_mov_b32 v99, 0
  v_mov_b32 v103, 0
  ds_read_b128 v[118:121], v125 offset:0
  s_waitcnt lgkmcnt(0)
  v_add_f32 v118, v118, v119
  v_add_f32 v120, v120, v121
  v_add_f32 v118, v118, v120
  v_cvt_pk_bf16_f32 v119, v118, v118
  v_mfma_f32_32x32x16_bf16 v[80:95], v[36:39], v[148:151], v[80:95]
  ds_read_b64_tr_b16 v[44:45], v13 offset:8192
  ds_read_b64_tr_b16 v[46:47], v13 offset:8704
  s_cmp_ge_u32 s70, 14
  s_cselect_b32 s71, 917504, 0
  s_sub_u32 s71, s60, s71
  s_add_u32 s71, s71, 0
  s_add_u32 m0, s64, 32768
  s_mov_b32 s57, s71
  buffer_load_dwordx4 v18, s[24:27], s57 offen lds
  v_and_b32 v120, s74, v119
  v_sub_f32 v120, v118, v120
  v_cvt_pk_bf16_f32 v100, v118, v120
  v_and_b32 v101, 0xffff, v119
  v_mov_b32 v102, 0
  s_nop 1
  v_mfma_f32_32x32x16_bf16 v[48:63], v[100:103], v[96:99], v[48:63]
  ds_read_b128 v[118:121], v125 offset:1024
  v_mfma_f32_32x32x16_bf16 v[80:95], v[40:43], v[152:155], v[80:95]
  ds_read_b64_tr_b16 v[32:33], v10 offset:16384
  ds_read_b64_tr_b16 v[34:35], v10 offset:16896
  s_waitcnt lgkmcnt(2)
  v_add_f32 v118, v118, v119
  v_add_f32 v120, v120, v121
  v_add_f32 v118, v118, v120
  v_cvt_pk_bf16_f32 v119, v118, v118
  v_and_b32 v120, s74, v119
  v_sub_f32 v120, v118, v120
  v_cvt_pk_bf16_f32 v100, v118, v120
  v_mfma_f32_32x32x16_bf16 v[80:95], v[44:47], v[156:159], v[80:95]
  ds_read_b64_tr_b16 v[36:37], v11 offset:16384
  ds_read_b64_tr_b16 v[38:39], v11 offset:16896
  v_perm_b32 v101, v107, v119, s101
  v_mov_b32 v102, v107
  s_nop 1
  v_mfma_f32_32x32x16_bf16 v[64:79], v[100:103], v[96:99], v[64:79]
  v_mul_f32 v48, v104, v48
  v_mul_f32 v49, v104, v49
  v_mul_f32 v50, v104, v50
  s_waitcnt lgkmcnt(2)
  v_mfma_f32_32x32x16_bf16 v[80:95], v[32:35], v[160:163], v[80:95]
  ds_read_b64_tr_b16 v[40:41], v12 offset:16384
  ds_read_b64_tr_b16 v[42:43], v12 offset:16896
  v_mul_f32 v51, v104, v51
  v_mul_f32 v52, v104, v52
  v_mul_f32 v53, v104, v53
  v_mul_f32 v54, v104, v54
  v_mul_f32 v55, v104, v55
  v_cvt_pk_bf16_f32 v48, v48, v49
  v_cvt_pk_bf16_f32 v49, v50, v51
  v_cvt_pk_bf16_f32 v50, v52, v53
  v_mfma_f32_16x16x32_bf16 v[24:27], v[2:5], v[32:35], v[24:27]
  s_add_u32 m0, s64, 33792
  s_add_u32 s57, s71, 8192
  buffer_load_dwordx4 v18, s[24:27], s57 offen lds
  v_cvt_pk_bf16_f32 v51, v54, v55
  buffer_store_dwordx4 v[48:51], v127, s[20:23], s84 offen sc1
  v_mul_f32 v56, v104, v56
  v_mul_f32 v57, v104, v57
  v_mul_f32 v58, v104, v58
  v_mul_f32 v59, v104, v59
  v_mul_f32 v60, v104, v60
  s_waitcnt lgkmcnt(2)
  v_mfma_f32_32x32x16_bf16 v[80:95], v[36:39], v[164:167], v[80:95]
  ds_read_b64_tr_b16 v[44:45], v13 offset:16384
  ds_read_b64_tr_b16 v[46:47], v13 offset:16896
  v_mul_f32 v61, v104, v61
  v_mul_f32 v62, v104, v62
  v_mul_f32 v63, v104, v63
  v_cvt_pk_bf16_f32 v52, v56, v57
  v_cvt_pk_bf16_f32 v53, v58, v59
  v_cvt_pk_bf16_f32 v54, v60, v61
  v_cvt_pk_bf16_f32 v55, v62, v63
  buffer_store_dwordx4 v[52:55], v127, s[20:23], s52 offen sc1
  v_mul_f32 v110, v64, v64
  v_mul_f32 v111, v65, v65
  v_mul_f32 v112, v66, v66
  v_mul_f32 v113, v67, v67
  v_fma_f32 v110, v110, v23, v22
  v_fma_f32 v111, v111, v23, v22
  s_waitcnt lgkmcnt(2)
  v_mfma_f32_32x32x16_bf16 v[80:95], v[40:43], v[168:171], v[80:95]
  ds_read_b64_tr_b16 v[32:33], v10 offset:24576
  ds_read_b64_tr_b16 v[34:35], v10 offset:25088
  v_fma_f32 v112, v112, v23, v22
  v_fma_f32 v113, v113, v23, v22
  v_mul_f32 v110, v110, v64
  v_mul_f32 v111, v111, v65
  v_mul_f32 v112, v112, v66
  v_mul_f32 v113, v113, v67
  s_waitcnt lgkmcnt(2)
  v_mfma_f32_32x32x16_bf16 v[80:95], v[44:47], v[172:175], v[80:95]
  ds_read_b64_tr_b16 v[36:37], v11 offset:24576
  ds_read_b64_tr_b16 v[38:39], v11 offset:25088
  v_exp_f32 v110, v110
  v_exp_f32 v111, v111
  v_exp_f32 v112, v112
  v_exp_f32 v113, v113
  s_waitcnt lgkmcnt(2)
  v_mfma_f32_32x32x16_bf16 v[80:95], v[32:35], v[176:179], v[80:95]
  ds_read_b64_tr_b16 v[40:41], v12 offset:24576
  ds_read_b64_tr_b16 v[42:43], v12 offset:25088
  s_cmp_ge_u32 s70, 13
  s_cselect_b32 s71, 917504, 0
  s_sub_u32 s71, s60, s71
  s_add_u32 s71, s71, 65536
  s_add_u32 m0, s64, 49152
  s_mov_b32 s57, s71
  buffer_load_dwordx4 v18, s[24:27], s57 offen lds
  v_add_f32 v110, 1.0, v110
  v_add_f32 v111, 1.0, v111
  v_add_f32 v112, 1.0, v112
  v_add_f32 v113, 1.0, v113
  v_rcp_f32 v110, v110
  v_mfma_f32_16x16x32_bf16 v[24:27], v[2:5], v[32:35], v[24:27]
  v_rcp_f32 v111, v111
  v_rcp_f32 v112, v112
  v_rcp_f32 v113, v113
  s_waitcnt vmcnt(5)
  s_barrier
  s_waitcnt lgkmcnt(2)
  v_mfma_f32_32x32x16_bf16 v[80:95], v[36:39], v[180:183], v[80:95]
  ds_read_b64_tr_b16 v[44:45], v13 offset:24576
  ds_read_b64_tr_b16 v[46:47], v13 offset:25088
  v_mul_f32 v64, v64, v110
  v_mul_f32 v65, v65, v111
  v_mul_f32 v66, v66, v112
  v_mul_f32 v67, v67, v113
  v_cvt_pk_bf16_f32 v64, v64, v65
  v_cvt_pk_bf16_f32 v65, v66, v67
  s_waitcnt lgkmcnt(2)
  v_mfma_f32_32x32x16_bf16 v[80:95], v[40:43], v[184:187], v[80:95]
  ds_read_b64_tr_b16 v[32:33], v10 offset:32768
  ds_read_b64_tr_b16 v[34:35], v10 offset:33280
  v_mul_f32 v110, v68, v68
  v_mul_f32 v111, v69, v69
  v_mul_f32 v112, v70, v70
  v_mul_f32 v113, v71, v71
  v_fma_f32 v110, v110, v23, v22
  v_fma_f32 v111, v111, v23, v22
  s_waitcnt lgkmcnt(2)
  v_mfma_f32_32x32x16_bf16 v[80:95], v[44:47], v[188:191], v[80:95]
  ds_read_b64_tr_b16 v[36:37], v10 offset:40960
  ds_read_b64_tr_b16 v[38:39], v10 offset:41472
  s_add_u32 m0, s64, 50176
  s_add_u32 s57, s71, 8192
  buffer_load_dwordx4 v18, s[24:27], s57 offen lds
  v_fma_f32 v112, v112, v23, v22
  v_fma_f32 v113, v113, v23, v22
  v_mul_f32 v110, v110, v68
  v_mul_f32 v111, v111, v69
  v_mul_f32 v112, v112, v70
  v_mul_f32 v113, v113, v71
  s_waitcnt lgkmcnt(2)
  v_mfma_f32_32x32x16_bf16 v[80:95], v[32:35], v[192:195], v[80:95]
  ds_read_b64_tr_b16 v[40:41], v10 offset:49152
  ds_read_b64_tr_b16 v[42:43], v10 offset:49664
  v_exp_f32 v110, v110
  v_exp_f32 v111, v111
  v_exp_f32 v112, v112
  v_exp_f32 v113, v113
  v_mfma_f32_16x16x32_bf16 v[24:27], v[2:5], v[32:35], v[24:27]
  v_add_f32 v110, 1.0, v110
  v_add_f32 v111, 1.0, v111
  v_add_f32 v112, 1.0, v112
  v_add_f32 v113, 1.0, v113
  v_rcp_f32 v110, v110
  s_waitcnt lgkmcnt(2)
  v_mfma_f32_32x32x16_bf16 v[80:95], v[36:39], v[208:211], v[80:95]
  ds_read_b64_tr_b16 v[44:45], v10 offset:57344
  ds_read_b64_tr_b16 v[46:47], v10 offset:57856
  v_rcp_f32 v111, v111
  v_rcp_f32 v112, v112
  v_rcp_f32 v113, v113
  v_mfma_f32_16x16x32_bf16 v[24:27], v[2:5], v[36:39], v[24:27]
  s_cmp_ge_u32 s70, 12
  s_cselect_b32 s71, 917504, 0
  s_sub_u32 s71, s60, s71
  s_add_u32 s71, s71, 131072
  s_add_u32 m0, s64, 65536
  s_mov_b32 s57, s71
  buffer_load_dwordx4 v18, s[24:27], s57 offen lds
  v_mul_f32 v68, v68, v110
  v_mul_f32 v69, v69, v111
  v_mul_f32 v70, v70, v112
  v_mul_f32 v71, v71, v113
  v_cvt_pk_bf16_f32 v66, v68, v69
  v_cvt_pk_bf16_f32 v67, v70, v71
  buffer_store_dwordx4 v[64:67], v127, s[20:23], s85 offen sc1
  s_waitcnt lgkmcnt(2)
  v_mfma_f32_32x32x16_bf16 v[80:95], v[40:43], v[224:227], v[80:95]
  ds_read_b64_tr_b16 v[32:33], v11 offset:32768
  ds_read_b64_tr_b16 v[34:35], v11 offset:33280
  v_mul_f32 v110, v72, v72
  v_mul_f32 v111, v73, v73
  v_mul_f32 v112, v74, v74
  v_mul_f32 v113, v75, v75
  v_fma_f32 v110, v110, v23, v22
  v_fma_f32 v111, v111, v23, v22
  v_mfma_f32_16x16x32_bf16 v[24:27], v[2:5], v[40:43], v[24:27]
  v_fma_f32 v112, v112, v23, v22
  v_fma_f32 v113, v113, v23, v22
  v_mul_f32 v110, v110, v72
  v_mul_f32 v111, v111, v73
  v_mul_f32 v112, v112, v74
  v_mul_f32 v113, v113, v75
  s_waitcnt lgkmcnt(2)
  v_mfma_f32_32x32x16_bf16 v[80:95], v[44:47], v[240:243], v[80:95]
  ds_read_b64_tr_b16 v[36:37], v12 offset:32768
  ds_read_b64_tr_b16 v[38:39], v12 offset:33280
  v_exp_f32 v110, v110
  v_exp_f32 v111, v111
  v_exp_f32 v112, v112
  v_exp_f32 v113, v113
  v_mfma_f32_16x16x32_bf16 v[24:27], v[2:5], v[44:47], v[24:27]
  s_add_u32 m0, s64, 66560
  s_add_u32 s57, s71, 8192
  buffer_load_dwordx4 v18, s[24:27], s57 offen lds
  v_add_f32 v110, 1.0, v110
  v_add_f32 v111, 1.0, v111
  v_add_f32 v112, 1.0, v112
  v_add_f32 v113, 1.0, v113
  v_rcp_f32 v110, v110
  s_waitcnt lgkmcnt(2)
  v_mfma_f32_32x32x16_bf16 v[80:95], v[32:35], v[196:199], v[80:95]
  ds_read_b64_tr_b16 v[40:41], v13 offset:32768
  ds_read_b64_tr_b16 v[42:43], v13 offset:33280
  v_rcp_f32 v111, v111
  v_rcp_f32 v112, v112
  v_rcp_f32 v113, v113
  ds_write_b32 v123, v24 offset:2048
  s_waitcnt lgkmcnt(3)
  v_mfma_f32_32x32x16_bf16 v[80:95], v[36:39], v[200:203], v[80:95]
  ds_read_b64_tr_b16 v[44:45], v11 offset:40960
  ds_read_b64_tr_b16 v[46:47], v11 offset:41472
  v_mul_f32 v72, v72, v110
  v_mul_f32 v73, v73, v111
  v_mul_f32 v74, v74, v112
  v_mul_f32 v75, v75, v113
  v_cvt_pk_bf16_f32 v68, v72, v73
  v_cvt_pk_bf16_f32 v69, v74, v75
  s_waitcnt lgkmcnt(3)
  v_mfma_f32_32x32x16_bf16 v[80:95], v[40:43], v[204:207], v[80:95]
  ds_read_b64_tr_b16 v[32:33], v12 offset:40960
  ds_read_b64_tr_b16 v[34:35], v12 offset:41472
  v_mul_f32 v110, v76, v76
  v_mul_f32 v111, v77, v77
  v_mul_f32 v112, v78, v78
  v_mul_f32 v113, v79, v79
  v_fma_f32 v110, v110, v23, v22
  v_fma_f32 v111, v111, v23, v22
  s_waitcnt lgkmcnt(2)
  v_mfma_f32_32x32x16_bf16 v[80:95], v[44:47], v[212:215], v[80:95]
  ds_read_b64_tr_b16 v[36:37], v13 offset:40960
  ds_read_b64_tr_b16 v[38:39], v13 offset:41472
  v_fma_f32 v112, v112, v23, v22
  v_fma_f32 v113, v113, v23, v22
  v_mul_f32 v110, v110, v76
  v_mul_f32 v111, v111, v77
  v_mul_f32 v112, v112, v78
  v_mul_f32 v113, v113, v79
  s_lshl2_add_u32 s99, s45, s43
  s_lshl_b32 s100, s44, 6
  s_add_u32 s99, s99, s100
  s_lshl_b32 s100, s48, 7
  s_add_u32 s99, s99, s100
  s_lshl_b32 s99, s99, 2
  s_add_u32 s99, s99, 15728640
  v_lshlrev_b32 v14, 9, v1
  v_mov_b32 v15, 1
  s_waitcnt vmcnt(5)
  s_mov_b64 exec, 0x1
  buffer_store_dword v15, v14, s[20:23], s99 offen sc1
  s_mov_b64 exec, -1
  s_waitcnt lgkmcnt(2)
  v_mfma_f32_32x32x16_bf16 v[80:95], v[32:35], v[216:219], v[80:95]
  ds_read_b64_tr_b16 v[40:41], v11 offset:49152
  ds_read_b64_tr_b16 v[42:43], v11 offset:49664
  v_exp_f32 v110, v110
  v_exp_f32 v111, v111
  v_exp_f32 v112, v112
  v_exp_f32 v113, v113
  s_waitcnt lgkmcnt(2)
  v_mfma_f32_32x32x16_bf16 v[80:95], v[36:39], v[220:223], v[80:95]
  ds_read_b64_tr_b16 v[44:45], v12 offset:49152
  ds_read_b64_tr_b16 v[46:47], v12 offset:49664
  v_add_f32 v110, 1.0, v110
  v_add_f32 v111, 1.0, v111
  v_add_f32 v112, 1.0, v112
  v_add_f32 v113, 1.0, v113
  v_rcp_f32 v110, v110
  s_waitcnt lgkmcnt(0)
  s_barrier
  v_mfma_f32_32x32x16_bf16 v[80:95], v[40:43], v[228:231], v[80:95]
  ds_read_b64_tr_b16 v[32:33], v13 offset:49152
  ds_read_b64_tr_b16 v[34:35], v13 offset:49664
  v_rcp_f32 v111, v111
  v_rcp_f32 v112, v112
  v_rcp_f32 v113, v113
  v_mfma_f32_32x32x16_bf16 v[80:95], v[44:47], v[232:235], v[80:95]
  ds_read_b64_tr_b16 v[36:37], v11 offset:57344
  ds_read_b64_tr_b16 v[38:39], v11 offset:57856
  v_mul_f32 v76, v76, v110
  v_mul_f32 v77, v77, v111
  v_mul_f32 v78, v78, v112
  v_mul_f32 v79, v79, v113
  v_cvt_pk_bf16_f32 v70, v76, v77
  v_cvt_pk_bf16_f32 v71, v78, v79
  buffer_store_dwordx4 v[68:71], v127, s[20:23], s85 offen offset:1024 sc1
  s_waitcnt lgkmcnt(2)
  v_mfma_f32_32x32x16_bf16 v[80:95], v[32:35], v[236:239], v[80:95]
  ds_read_b64_tr_b16 v[40:41], v12 offset:57344
  ds_read_b64_tr_b16 v[42:43], v12 offset:57856
  ds_read_b128 v[118:121], v125 offset:2048
  s_waitcnt lgkmcnt(0)
  v_add_f32 v118, v118, v119
  v_add_f32 v120, v120, v121
  v_mfma_f32_32x32x16_bf16 v[80:95], v[36:39], v[244:247], v[80:95]
  ds_read_b64_tr_b16 v[44:45], v13 offset:57344
  ds_read_b64_tr_b16 v[46:47], v13 offset:57856
  v_add_f32 v118, v118, v120
  v_cvt_pk_bf16_f32 v119, v118, v118
  v_and_b32 v120, s74, v119
  v_sub_f32 v120, v118, v120
  v_mfma_f32_32x32x16_bf16 v[80:95], v[40:43], v[248:251], v[80:95]
  v_cvt_pk_bf16_f32 v100, v118, v120
  v_perm_b32 v101, v108, v119, s101
  v_mov_b32 v102, v108
  s_waitcnt lgkmcnt(0)
  v_mfma_f32_32x32x16_bf16 v[80:95], v[44:47], v[252:255], v[80:95]
  v_mfma_f32_32x32x16_bf16 v[80:95], v[100:103], v[96:99], v[80:95]
  s_nop 11
L_passB_done_12:
  s_lshl_b32 s92, s88, 2
  s_and_b32 s99, s89, 3
  s_add_u32 s92, s92, s99
  s_lshr_b32 s93, s89, 2
  s_cmp_eq_u32 s96, 1
  s_cbranch_scc1 L_passC_typ1_21
  s_cmp_eq_u32 s44, 1
  s_cbranch_scc1 L_passC_nw1_18
  ds_read_b64_tr_b16 v[32:33], v6 offset:0
  ds_read_b64_tr_b16 v[34:35], v6 offset:256
  ds_read_b64_tr_b16 v[36:37], v7 offset:0
  ds_read_b64_tr_b16 v[38:39], v7 offset:256
  s_waitcnt lgkmcnt(2)
  v_mfma_f32_32x32x16_bf16 v[48:63], v[32:35], v[128:131], 0
  ds_read_b64_tr_b16 v[40:41], v8 offset:0
  ds_read_b64_tr_b16 v[42:43], v8 offset:256
  v_mul_f32 v110, v80, v80
  v_mul_f32 v111, v81, v81
  v_mul_f32 v112, v82, v82
  v_mul_f32 v113, v83, v83
  v_fma_f32 v110, v110, v23, v22
  s_waitcnt lgkmcnt(2)
  v_mfma_f32_32x32x16_bf16 v[48:63], v[36:39], v[132:135], v[48:63]
  ds_read_b64_tr_b16 v[44:45], v9 offset:0
  ds_read_b64_tr_b16 v[46:47], v9 offset:256
  v_fma_f32 v111, v111, v23, v22
  v_fma_f32 v112, v112, v23, v22
  v_fma_f32 v113, v113, v23, v22
  v_mul_f32 v110, v110, v80
  v_mul_f32 v111, v111, v81
  v_mul_f32 v112, v112, v82
  s_waitcnt lgkmcnt(2)
  v_mfma_f32_32x32x16_bf16 v[48:63], v[40:43], v[136:139], v[48:63]
  ds_read_b64_tr_b16 v[32:33], v6 offset:4096
  ds_read_b64_tr_b16 v[34:35], v6 offset:4352
  v_mul_f32 v113, v113, v83
  v_exp_f32 v110, v110
  v_exp_f32 v111, v111
  s_waitcnt lgkmcnt(2)
  v_mfma_f32_32x32x16_bf16 v[48:63], v[44:47], v[140:143], v[48:63]
  ds_read_b64_tr_b16 v[36:37], v7 offset:4096
  ds_read_b64_tr_b16 v[38:39], v7 offset:4352
  v_exp_f32 v112, v112
  v_exp_f32 v113, v113
  v_add_f32 v110, 1.0, v110
  v_add_f32 v111, 1.0, v111
  s_waitcnt lgkmcnt(2)
  v_mfma_f32_32x32x16_bf16 v[48:63], v[32:35], v[144:147], v[48:63]
  ds_read_b64_tr_b16 v[40:41], v8 offset:4096
  ds_read_b64_tr_b16 v[42:43], v8 offset:4352
  v_add_f32 v112, 1.0, v112
  v_add_f32 v113, 1.0, v113
  v_rcp_f32 v110, v110
  v_rcp_f32 v111, v111
  s_waitcnt lgkmcnt(2)
  v_mfma_f32_32x32x16_bf16 v[48:63], v[36:39], v[148:151], v[48:63]
  ds_read_b64_tr_b16 v[44:45], v9 offset:4096
  ds_read_b64_tr_b16 v[46:47], v9 offset:4352
  v_rcp_f32 v112, v112
  v_rcp_f32 v113, v113
  v_mul_f32 v80, v80, v110
  s_waitcnt lgkmcnt(2)
  v_mfma_f32_32x32x16_bf16 v[48:63], v[40:43], v[152:155], v[48:63]
  ds_read_b64_tr_b16 v[32:33], v6 offset:8192
  ds_read_b64_tr_b16 v[34:35], v6 offset:8448
  v_mul_f32 v81, v81, v111
  v_mul_f32 v82, v82, v112
  v_mul_f32 v83, v83, v113
  v_cvt_pk_bf16_f32 v80, v80, v81
  v_cvt_pk_bf16_f32 v81, v82, v83
  s_waitcnt lgkmcnt(2)
  v_mfma_f32_32x32x16_bf16 v[48:63], v[44:47], v[156:159], v[48:63]
  ds_read_b64_tr_b16 v[36:37], v7 offset:8192
  ds_read_b64_tr_b16 v[38:39], v7 offset:8448
  v_mul_f32 v110, v84, v84
  v_mul_f32 v111, v85, v85
  v_mul_f32 v112, v86, v86
  v_mul_f32 v113, v87, v87
  v_fma_f32 v110, v110, v23, v22
  v_fma_f32 v111, v111, v23, v22
  s_waitcnt lgkmcnt(0)
  s_barrier
  v_mfma_f32_32x32x16_bf16 v[48:63], v[32:35], v[160:163], v[48:63]
  ds_read_b64_tr_b16 v[40:41], v8 offset:8192
  ds_read_b64_tr_b16 v[42:43], v8 offset:8448
  v_fma_f32 v112, v112, v23, v22
  v_fma_f32 v113, v113, v23, v22
  v_mul_f32 v110, v110, v84
  v_mul_f32 v111, v111, v85
  v_mul_f32 v112, v112, v86
  v_mfma_f32_32x32x16_bf16 v[48:63], v[36:39], v[164:167], v[48:63]
  ds_read_b64_tr_b16 v[44:45], v9 offset:8192
  ds_read_b64_tr_b16 v[46:47], v9 offset:8448
  s_cmp_ge_u32 s70, 11
  s_cselect_b32 s71, 917504, 0
  s_sub_u32 s71, s60, s71
  s_add_u32 s71, s71, 196608
  s_add_u32 m0, s64, 98304
  s_mov_b32 s57, s71
  buffer_load_dwordx4 v18, s[24:27], s57 offen lds
  v_mul_f32 v113, v113, v87
  v_exp_f32 v110, v110
  v_exp_f32 v111, v111
  s_waitcnt lgkmcnt(2)
  v_mfma_f32_32x32x16_bf16 v[48:63], v[40:43], v[168:171], v[48:63]
  ds_read_b64_tr_b16 v[32:33], v6 offset:12288
  ds_read_b64_tr_b16 v[34:35], v6 offset:12544
  s_add_u32 m0, s64, 99328
  s_add_u32 s57, s71, 8192
  buffer_load_dwordx4 v18, s[24:27], s57 offen lds
  v_exp_f32 v112, v112
  v_exp_f32 v113, v113
  v_add_f32 v110, 1.0, v110
  v_add_f32 v111, 1.0, v111
  s_waitcnt lgkmcnt(2)
  v_mfma_f32_32x32x16_bf16 v[48:63], v[44:47], v[172:175], v[48:63]
  ds_read_b64_tr_b16 v[36:37], v7 offset:12288
  ds_read_b64_tr_b16 v[38:39], v7 offset:12544
  v_add_f32 v112, 1.0, v112
  v_add_f32 v113, 1.0, v113
  v_rcp_f32 v110, v110
  v_rcp_f32 v111, v111
  s_waitcnt lgkmcnt(2)
  v_mfma_f32_32x32x16_bf16 v[48:63], v[32:35], v[176:179], v[48:63]
  ds_read_b64_tr_b16 v[40:41], v8 offset:12288
  ds_read_b64_tr_b16 v[42:43], v8 offset:12544
  v_rcp_f32 v112, v112
  v_rcp_f32 v113, v113
  v_mul_f32 v84, v84, v110
  s_waitcnt lgkmcnt(2)
  v_mfma_f32_32x32x16_bf16 v[48:63], v[36:39], v[180:183], v[48:63]
  ds_read_b64_tr_b16 v[44:45], v9 offset:12288
  ds_read_b64_tr_b16 v[46:47], v9 offset:12544
  v_mul_f32 v85, v85, v111
  v_mul_f32 v86, v86, v112
  v_mul_f32 v87, v87, v113
  v_cvt_pk_bf16_f32 v82, v84, v85
  v_cvt_pk_bf16_f32 v83, v86, v87
  buffer_store_dwordx4 v[80:83], v127, s[20:23], s86 offen sc1
  s_waitcnt lgkmcnt(2)
  v_mfma_f32_32x32x16_bf16 v[48:63], v[40:43], v[184:187], v[48:63]
  ds_read_b64_tr_b16 v[32:33], v6 offset:16384
  ds_read_b64_tr_b16 v[34:35], v6 offset:16640
  v_mul_f32 v110, v88, v88
  v_mul_f32 v111, v89, v89
  v_mul_f32 v112, v90, v90
  v_mul_f32 v113, v91, v91
  v_fma_f32 v110, v110, v23, v22
  s_waitcnt lgkmcnt(2)
  v_mfma_f32_32x32x16_bf16 v[48:63], v[44:47], v[188:191], v[48:63]
  ds_read_b64_tr_b16 v[36:37], v7 offset:16384
  ds_read_b64_tr_b16 v[38:39], v7 offset:16640
  v_fma_f32 v111, v111, v23, v22
  v_fma_f32 v112, v112, v23, v22
  v_fma_f32 v113, v113, v23, v22
  v_mul_f32 v110, v110, v88
  v_mul_f32 v111, v111, v89
  v_mul_f32 v112, v112, v90
  s_waitcnt lgkmcnt(2)
  v_mfma_f32_32x32x16_bf16 v[48:63], v[32:35], v[192:195], v[48:63]
  ds_read_b64_tr_b16 v[40:41], v8 offset:16384
  ds_read_b64_tr_b16 v[42:43], v8 offset:16640
  v_mul_f32 v113, v113, v91
  v_exp_f32 v110, v110
  v_exp_f32 v111, v111
  s_waitcnt lgkmcnt(2)
  v_mfma_f32_32x32x16_bf16 v[48:63], v[36:39], v[196:199], v[48:63]
  ds_read_b64_tr_b16 v[44:45], v9 offset:16384
  ds_read_b64_tr_b16 v[46:47], v9 offset:16640
  v_exp_f32 v112, v112
  v_exp_f32 v113, v113
  v_add_f32 v110, 1.0, v110
  v_add_f32 v111, 1.0, v111
  s_waitcnt lgkmcnt(2)
  v_mfma_f32_32x32x16_bf16 v[48:63], v[40:43], v[200:203], v[48:63]
  ds_read_b64_tr_b16 v[32:33], v6 offset:20480
  ds_read_b64_tr_b16 v[34:35], v6 offset:20736
  v_add_f32 v112, 1.0, v112
  v_add_f32 v113, 1.0, v113
  v_rcp_f32 v110, v110
  v_rcp_f32 v111, v111
  s_waitcnt lgkmcnt(2)
  v_mfma_f32_32x32x16_bf16 v[48:63], v[44:47], v[204:207], v[48:63]
  ds_read_b64_tr_b16 v[36:37], v7 offset:20480
  ds_read_b64_tr_b16 v[38:39], v7 offset:20736
  v_rcp_f32 v112, v112
  v_rcp_f32 v113, v113
  v_mul_f32 v88, v88, v110
  s_waitcnt lgkmcnt(2)
  v_mfma_f32_32x32x16_bf16 v[48:63], v[32:35], v[208:211], v[48:63]
  ds_read_b64_tr_b16 v[40:41], v8 offset:20480
  ds_read_b64_tr_b16 v[42:43], v8 offset:20736
  v_mul_f32 v89, v89, v111
  v_mul_f32 v90, v90, v112
  v_mul_f32 v91, v91, v113
  v_cvt_pk_bf16_f32 v84, v88, v89
  v_cvt_pk_bf16_f32 v85, v90, v91
  s_waitcnt lgkmcnt(2)
  v_mfma_f32_32x32x16_bf16 v[48:63], v[36:39], v[212:215], v[48:63]
  ds_read_b64_tr_b16 v[44:45], v9 offset:20480
  ds_read_b64_tr_b16 v[46:47], v9 offset:20736
  v_mul_f32 v110, v92, v92
  v_mul_f32 v111, v93, v93
  v_mul_f32 v112, v94, v94
  v_mul_f32 v113, v95, v95
  v_fma_f32 v110, v110, v23, v22
  v_fma_f32 v111, v111, v23, v22
  s_waitcnt lgkmcnt(2)
  v_mfma_f32_32x32x16_bf16 v[48:63], v[40:43], v[216:219], v[48:63]
  ds_read_b64_tr_b16 v[32:33], v6 offset:24576
  ds_read_b64_tr_b16 v[34:35], v6 offset:24832
  v_fma_f32 v112, v112, v23, v22
  v_fma_f32 v113, v113, v23, v22
  v_mul_f32 v110, v110, v92
  v_mul_f32 v111, v111, v93
  v_mul_f32 v112, v112, v94
  s_waitcnt lgkmcnt(2)
  v_mfma_f32_32x32x16_bf16 v[48:63], v[44:47], v[220:223], v[48:63]
  ds_read_b64_tr_b16 v[36:37], v7 offset:24576
  ds_read_b64_tr_b16 v[38:39], v7 offset:24832
  v_mul_f32 v113, v113, v95
  v_exp_f32 v110, v110
  v_exp_f32 v111, v111
  s_waitcnt lgkmcnt(2)
  v_mfma_f32_32x32x16_bf16 v[48:63], v[32:35], v[224:227], v[48:63]
  ds_read_b64_tr_b16 v[40:41], v8 offset:24576
  ds_read_b64_tr_b16 v[42:43], v8 offset:24832
  v_exp_f32 v112, v112
  v_exp_f32 v113, v113
  v_add_f32 v110, 1.0, v110
  v_add_f32 v111, 1.0, v111
  s_waitcnt lgkmcnt(2)
  v_mfma_f32_32x32x16_bf16 v[48:63], v[36:39], v[228:231], v[48:63]
  ds_read_b64_tr_b16 v[44:45], v9 offset:24576
  ds_read_b64_tr_b16 v[46:47], v9 offset:24832
  v_add_f32 v112, 1.0, v112
  v_add_f32 v113, 1.0, v113
  v_rcp_f32 v110, v110
  v_rcp_f32 v111, v111
  s_waitcnt lgkmcnt(2)
  v_mfma_f32_32x32x16_bf16 v[48:63], v[40:43], v[232:235], v[48:63]
  ds_read_b64_tr_b16 v[32:33], v6 offset:28672
  ds_read_b64_tr_b16 v[34:35], v6 offset:28928
  v_rcp_f32 v112, v112
  v_rcp_f32 v113, v113
  v_mul_f32 v92, v92, v110
  s_waitcnt lgkmcnt(2)
  v_mfma_f32_32x32x16_bf16 v[48:63], v[44:47], v[236:239], v[48:63]
  ds_read_b64_tr_b16 v[36:37], v7 offset:28672
  ds_read_b64_tr_b16 v[38:39], v7 offset:28928
  v_mul_f32 v93, v93, v111
  v_mul_f32 v94, v94, v112
  v_mul_f32 v95, v95, v113
  v_cvt_pk_bf16_f32 v86, v92, v93
  v_cvt_pk_bf16_f32 v87, v94, v95
  buffer_store_dwordx4 v[84:87], v127, s[20:23], s86 offen offset:1024 sc1
  ds_read_b128 v[118:121], v125 offset:3072
  s_waitcnt lgkmcnt(0)
  v_add_f32 v118, v118, v119
  v_mfma_f32_32x32x16_bf16 v[48:63], v[32:35], v[240:243], v[48:63]
  ds_read_b64_tr_b16 v[40:41], v8 offset:28672
  ds_read_b64_tr_b16 v[42:43], v8 offset:28928
  v_add_f32 v120, v120, v121
  v_add_f32 v118, v118, v120
  v_cvt_pk_bf16_f32 v119, v118, v118
  v_mfma_f32_32x32x16_bf16 v[48:63], v[36:39], v[244:247], v[48:63]
  ds_read_b64_tr_b16 v[44:45], v9 offset:28672
  ds_read_b64_tr_b16 v[46:47], v9 offset:28928
  v_and_b32 v120, s74, v119
  v_sub_f32 v120, v118, v120
  s_waitcnt lgkmcnt(2)
  v_mfma_f32_32x32x16_bf16 v[48:63], v[40:43], v[248:251], v[48:63]
  v_cvt_pk_bf16_f32 v100, v118, v120
  v_perm_b32 v101, v109, v119, s101
  v_mov_b32 v102, v109
  s_waitcnt lgkmcnt(0)
  v_mfma_f32_32x32x16_bf16 v[48:63], v[44:47], v[252:255], v[48:63]
  v_mfma_f32_32x32x16_bf16 v[48:63], v[100:103], v[96:99], v[48:63]
  s_nop 11
  v_mul_f32 v110, v48, v48
  v_mul_f32 v111, v49, v49
  v_mul_f32 v112, v50, v50
  v_mul_f32 v113, v51, v51
  v_fma_f32 v110, v110, v23, v22
  v_fma_f32 v111, v111, v23, v22
  v_fma_f32 v112, v112, v23, v22
  v_fma_f32 v113, v113, v23, v22
  v_mul_f32 v110, v110, v48
  v_mul_f32 v111, v111, v49
  v_mul_f32 v112, v112, v50
  v_mul_f32 v113, v113, v51
  v_exp_f32 v110, v110
  v_exp_f32 v111, v111
  v_exp_f32 v112, v112
  v_exp_f32 v113, v113
  v_add_f32 v110, 1.0, v110
  v_add_f32 v111, 1.0, v111
  v_add_f32 v112, 1.0, v112
  v_add_f32 v113, 1.0, v113
  v_rcp_f32 v110, v110
  v_rcp_f32 v111, v111
  v_rcp_f32 v112, v112
  v_rcp_f32 v113, v113
  v_mul_f32 v48, v48, v110
  v_mul_f32 v49, v49, v111
  v_mul_f32 v50, v50, v112
  v_mul_f32 v51, v51, v113
  v_cvt_pk_bf16_f32 v48, v48, v49
  v_cvt_pk_bf16_f32 v49, v50, v51
  v_mul_f32 v110, v52, v52
  v_mul_f32 v111, v53, v53
  v_mul_f32 v112, v54, v54
  v_mul_f32 v113, v55, v55
  v_fma_f32 v110, v110, v23, v22
  v_fma_f32 v111, v111, v23, v22
  v_fma_f32 v112, v112, v23, v22
  v_fma_f32 v113, v113, v23, v22
  v_mul_f32 v110, v110, v52
  v_mul_f32 v111, v111, v53
  v_mul_f32 v112, v112, v54
  v_mul_f32 v113, v113, v55
  v_exp_f32 v110, v110
  v_exp_f32 v111, v111
  v_exp_f32 v112, v112
  v_exp_f32 v113, v113
  v_add_f32 v110, 1.0, v110
  v_add_f32 v111, 1.0, v111
  v_add_f32 v112, 1.0, v112
  v_add_f32 v113, 1.0, v113
  v_rcp_f32 v110, v110
  v_rcp_f32 v111, v111
  v_rcp_f32 v112, v112
  v_rcp_f32 v113, v113
  v_mul_f32 v52, v52, v110
  v_mul_f32 v53, v53, v111
  v_mul_f32 v54, v54, v112
  v_mul_f32 v55, v55, v113
  v_cvt_pk_bf16_f32 v50, v52, v53
  v_cvt_pk_bf16_f32 v51, v54, v55
  buffer_store_dwordx4 v[48:51], v127, s[20:23], s87 offen sc1
  v_mul_f32 v110, v56, v56
  v_mul_f32 v111, v57, v57
  v_mul_f32 v112, v58, v58
  v_mul_f32 v113, v59, v59
  v_fma_f32 v110, v110, v23, v22
  v_fma_f32 v111, v111, v23, v22
  v_fma_f32 v112, v112, v23, v22
  v_fma_f32 v113, v113, v23, v22
  v_mul_f32 v110, v110, v56
  v_mul_f32 v111, v111, v57
  v_mul_f32 v112, v112, v58
  v_mul_f32 v113, v113, v59
  v_exp_f32 v110, v110
  v_exp_f32 v111, v111
  v_exp_f32 v112, v112
  v_exp_f32 v113, v113
  v_add_f32 v110, 1.0, v110
  v_add_f32 v111, 1.0, v111
  v_add_f32 v112, 1.0, v112
  v_add_f32 v113, 1.0, v113
  v_rcp_f32 v110, v110
  v_rcp_f32 v111, v111
  v_rcp_f32 v112, v112
  v_rcp_f32 v113, v113
  v_mul_f32 v56, v56, v110
  v_mul_f32 v57, v57, v111
  v_mul_f32 v58, v58, v112
  v_mul_f32 v59, v59, v113
  v_cvt_pk_bf16_f32 v52, v56, v57
  v_cvt_pk_bf16_f32 v53, v58, v59
  v_mul_f32 v110, v60, v60
  v_mul_f32 v111, v61, v61
  v_mul_f32 v112, v62, v62
  v_mul_f32 v113, v63, v63
  v_fma_f32 v110, v110, v23, v22
  v_fma_f32 v111, v111, v23, v22
  v_fma_f32 v112, v112, v23, v22
  v_fma_f32 v113, v113, v23, v22
  v_mul_f32 v110, v110, v60
  v_mul_f32 v111, v111, v61
  v_mul_f32 v112, v112, v62
  v_mul_f32 v113, v113, v63
  v_exp_f32 v110, v110
  v_exp_f32 v111, v111
  v_exp_f32 v112, v112
  v_exp_f32 v113, v113
  v_add_f32 v110, 1.0, v110
  v_add_f32 v111, 1.0, v111
  v_add_f32 v112, 1.0, v112
  v_add_f32 v113, 1.0, v113
  v_rcp_f32 v110, v110
  v_rcp_f32 v111, v111
  v_rcp_f32 v112, v112
  v_rcp_f32 v113, v113
  v_mul_f32 v60, v60, v110
  v_mul_f32 v61, v61, v111
  v_mul_f32 v62, v62, v112
  v_mul_f32 v63, v63, v113
  v_cvt_pk_bf16_f32 v54, v60, v61
  v_cvt_pk_bf16_f32 v55, v62, v63
  buffer_store_dwordx4 v[52:55], v127, s[20:23], s87 offen offset:1024 sc1
  v_lshlrev_b32 v252, 4, v1
  s_mov_b32 s72, 0
  v_lshrrev_b32 v242, 2, v1
  v_and_b32 v243, 3, v1
  v_mul_u32_u24 v244, 1088, v242
  v_lshl_add_u32 v244, v243, 3, v244
  v_add_u32 v244, 132096, v244
  s_cmp_eq_u32 s93, 0
  s_cselect_b32 s99, 8, 0
  v_cmp_le_u32 vcc, s99, v242
  v_mov_b32 v246, 0x3f80
  s_nop 0
  v_cndmask_b32 v246, 0, v246, vcc
  v_cmp_gt_u32 vcc, 2, v243
  s_nop 1
  v_cndmask_b32 v246, 0, v246, vcc
  v_mov_b32 v247, 0
  ds_write_b64 v244, v[246:247]
  v_mov_b32 v244, 156736
  ds_write_b32 v244, v247
  s_lshl_b32 s99, s42, 10
  s_add_u32 s100, s99, 114688
  v_add_u32 v236, s100, v252
  s_add_u32 s100, s99, 148480
  v_add_u32 v241, s100, v252
  v_bfe_u32 v242, v1, 1, 1
  v_lshlrev_b32 v242, 3, v242
  v_bfe_u32 v243, v1, 2, 2
  v_lshl_or_b32 v242, v243, 4, v242
  v_lshrrev_b32 v244, 5, v1
  v_lshl_or_b32 v242, v244, 6, v242
  v_and_b32 v243, 1, v1
  v_lshl_or_b32 v242, v243, 9, v242
  v_and_b32 v243, 3, v1
  v_lshlrev_b32 v243, 3, v243
  v_or_b32 v243, 0x400, v243
  v_and_b32 v245, 16, v1
  v_cmp_eq_u32 vcc, 0, v245
  s_mul_i32 s99, s42, 1088
  s_add_u32 s99, s99, 131072
  v_mov_b32 v245, 0x80
  v_cndmask_b32 v242, v243, v242, vcc
  v_cndmask_b32 v245, 0, v245, vcc
  v_add_u32 v237, s99, v242
  v_add_u32 v238, v237, v245
  v_add_u32 v239, v238, v245
  v_add_u32 v240, v239, v245
  v_and_b32 v242, 31, v1
  v_lshlrev_b32 v244, 2, v244
  v_sub_u32 v242, v242, v244
  v_mov_b32 v243, 0xf149f2ca
  v_cmp_gt_i32 s[52:53], 0, v242
  v_cmp_gt_i32 s[54:55], 1, v242
  v_cmp_gt_i32 s[56:57], 2, v242
  v_cmp_gt_i32 s[58:59], 3, v242
  v_cndmask_b32 v204, v243, 0, s[52:53]
  v_cndmask_b32 v220, 0, v243, s[52:53]
  v_cndmask_b32 v205, v243, 0, s[54:55]
  v_cndmask_b32 v221, 0, v243, s[54:55]
  v_cndmask_b32 v206, v243, 0, s[56:57]
  v_cndmask_b32 v222, 0, v243, s[56:57]
  v_cndmask_b32 v207, v243, 0, s[58:59]
  v_cndmask_b32 v223, 0, v243, s[58:59]
  v_cmp_gt_i32 s[52:53], 8, v242
  v_cmp_gt_i32 s[54:55], 9, v242
  v_cmp_gt_i32 s[56:57], 10, v242
  v_cmp_gt_i32 s[58:59], 11, v242
  v_cndmask_b32 v208, v243, 0, s[52:53]
  v_cndmask_b32 v224, 0, v243, s[52:53]
  v_cndmask_b32 v209, v243, 0, s[54:55]
  v_cndmask_b32 v225, 0, v243, s[54:55]
  v_cndmask_b32 v210, v243, 0, s[56:57]
  v_cndmask_b32 v226, 0, v243, s[56:57]
  v_cndmask_b32 v211, v243, 0, s[58:59]
  v_cndmask_b32 v227, 0, v243, s[58:59]
  v_cmp_gt_i32 s[52:53], 16, v242
  v_cmp_gt_i32 s[54:55], 17, v242
  v_cmp_gt_i32 s[56:57], 18, v242
  v_cmp_gt_i32 s[58:59], 19, v242
  v_cndmask_b32 v212, v243, 0, s[52:53]
  v_cndmask_b32 v228, 0, v243, s[52:53]
  v_cndmask_b32 v213, v243, 0, s[54:55]
  v_cndmask_b32 v229, 0, v243, s[54:55]
  v_cndmask_b32 v214, v243, 0, s[56:57]
  v_cndmask_b32 v230, 0, v243, s[56:57]
  v_cndmask_b32 v215, v243, 0, s[58:59]
  v_cndmask_b32 v231, 0, v243, s[58:59]
  v_cmp_gt_i32 s[52:53], 24, v242
  v_cmp_gt_i32 s[54:55], 25, v242
  v_cmp_gt_i32 s[56:57], 26, v242
  v_cmp_gt_i32 s[58:59], 27, v242
  v_cndmask_b32 v216, v243, 0, s[52:53]
  v_cndmask_b32 v232, 0, v243, s[52:53]
  v_cndmask_b32 v217, v243, 0, s[54:55]
  v_cndmask_b32 v233, 0, v243, s[54:55]
  v_cndmask_b32 v218, v243, 0, s[56:57]
  v_cndmask_b32 v234, 0, v243, s[56:57]
  v_cndmask_b32 v219, v243, 0, s[58:59]
  v_cndmask_b32 v235, 0, v243, s[58:59]
  s_waitcnt vmcnt(4)
  s_waitcnt lgkmcnt(0)
  s_branch L_passC_done_20
L_passC_nw1_18:
  ds_read_b64_tr_b16 v[32:33], v6 offset:0
  ds_read_b64_tr_b16 v[34:35], v6 offset:256
  ds_read_b64_tr_b16 v[36:37], v6 offset:4096
  ds_read_b64_tr_b16 v[38:39], v6 offset:4352
  s_waitcnt lgkmcnt(2)
  v_mfma_f32_16x16x32_bf16 v[24:27], v[2:5], v[32:35], 0
  ds_read_b64_tr_b16 v[40:41], v6 offset:8192
  ds_read_b64_tr_b16 v[42:43], v6 offset:8448
  s_waitcnt lgkmcnt(2)
  v_mfma_f32_16x16x32_bf16 v[24:27], v[2:5], v[36:39], v[24:27]
  ds_read_b64_tr_b16 v[44:45], v6 offset:12288
  ds_read_b64_tr_b16 v[46:47], v6 offset:12544
  s_waitcnt lgkmcnt(2)
  v_mfma_f32_16x16x32_bf16 v[24:27], v[2:5], v[40:43], v[24:27]
  ds_read_b64_tr_b16 v[32:33], v6 offset:16384
  ds_read_b64_tr_b16 v[34:35], v6 offset:16640
  s_waitcnt lgkmcnt(2)
  v_mfma_f32_16x16x32_bf16 v[24:27], v[2:5], v[44:47], v[24:27]
  ds_read_b64_tr_b16 v[36:37], v6 offset:20480
  ds_read_b64_tr_b16 v[38:39], v6 offset:20736
  s_waitcnt lgkmcnt(2)
  v_mfma_f32_16x16x32_bf16 v[24:27], v[2:5], v[32:35], v[24:27]
  ds_read_b64_tr_b16 v[40:41], v6 offset:24576
  ds_read_b64_tr_b16 v[42:43], v6 offset:24832
  s_waitcnt lgkmcnt(2)
  v_mfma_f32_16x16x32_bf16 v[24:27], v[2:5], v[36:39], v[24:27]
  ds_read_b64_tr_b16 v[44:45], v6 offset:28672
  ds_read_b64_tr_b16 v[46:47], v6 offset:28928
  s_waitcnt lgkmcnt(2)
  v_mfma_f32_16x16x32_bf16 v[24:27], v[2:5], v[40:43], v[24:27]
  s_waitcnt lgkmcnt(0)
  v_mfma_f32_16x16x32_bf16 v[24:27], v[2:5], v[44:47], v[24:27]
  s_nop 7
  ds_write_b32 v123, v24 offset:2560
  s_waitcnt lgkmcnt(0)
  s_barrier
  s_branch L_passC_common_17
L_passC_typ1_21:
  s_barrier
L_passC_common_17:
  s_cmp_ge_u32 s70, 11
  s_cselect_b32 s71, 917504, 0
  s_sub_u32 s71, s60, s71
  s_add_u32 s71, s71, 196608
  s_add_u32 m0, s64, 98304
  s_mov_b32 s57, s71
  buffer_load_dwordx4 v18, s[24:27], s57 offen lds
  s_add_u32 m0, s64, 99328
  s_add_u32 s57, s71, 8192
  buffer_load_dwordx4 v18, s[24:27], s57 offen lds
  s_lshl_b32 s99, s96, 2
  s_xor_b32 s99, s99, 4
  s_cmp_lg_u32 s42, s99
  s_cbranch_scc1 L_plain_22
  v_lshlrev_b32 v252, 4, v1
  s_setprio 1
  v_lshrrev_b32 v242, 4, v1
  v_and_b32 v243, 15, v1
  s_lshl_b32 s99, s93, 3
  s_sub_u32 s100, s99, 8
  v_add_u32 v244, s100, v243
  v_max_i32 v244, 0, v244
  v_add_u32 v245, s99, v243
  v_cmp_eq_u32 vcc, 2, v242
  s_nop 1
  v_cndmask_b32 v244, v244, v245, vcc
  v_add_u32 v245, 1, v242
  v_lshlrev_b32 v245, 3, v245
  v_cndmask_b32 v245, v245, 0, vcc
  v_add_u32 v245, s88, v245
  s_lshr_b32 s99, s92, 1
  s_and_b32 s99, s99, 1
  s_lshl_b32 s99, s99, 6
  v_lshlrev_b32 v245, 7, v245
  v_add_u32 v244, v244, v245
  v_add_u32 v244, s99, v244
  v_lshlrev_b32 v254, 2, v244
  s_mov_b32 s65, 15728640
  v_mul_f32 v110, v80, v80
  v_mul_f32 v111, v81, v81
  v_mul_f32 v112, v82, v82
  v_mul_f32 v113, v83, v83
  v_fma_f32 v110, v110, v23, v22
  v_fma_f32 v111, v111, v23, v22
  v_fma_f32 v112, v112, v23, v22
  v_fma_f32 v113, v113, v23, v22
  v_mul_f32 v110, v110, v80
  v_mul_f32 v111, v111, v81
  v_mul_f32 v112, v112, v82
  v_mul_f32 v113, v113, v83
  v_exp_f32 v110, v110
  v_exp_f32 v111, v111
  v_exp_f32 v112, v112
  v_exp_f32 v113, v113
  v_add_f32 v110, 1.0, v110
  v_add_f32 v111, 1.0, v111
  v_add_f32 v112, 1.0, v112
  v_add_f32 v113, 1.0, v113
  v_rcp_f32 v110, v110
  v_rcp_f32 v111, v111
  v_rcp_f32 v112, v112
  v_rcp_f32 v113, v113
  v_mul_f32 v80, v80, v110
  v_mul_f32 v81, v81, v111
  v_mul_f32 v82, v82, v112
  v_mul_f32 v83, v83, v113
  v_cvt_pk_bf16_f32 v80, v80, v81
  v_cvt_pk_bf16_f32 v81, v82, v83
  v_mul_f32 v110, v84, v84
  v_mul_f32 v111, v85, v85
  v_mul_f32 v112, v86, v86
  v_mul_f32 v113, v87, v87
  v_fma_f32 v110, v110, v23, v22
  v_fma_f32 v111, v111, v23, v22
  v_fma_f32 v112, v112, v23, v22
  v_fma_f32 v113, v113, v23, v22
  v_mul_f32 v110, v110, v84
  v_mul_f32 v111, v111, v85
  v_mul_f32 v112, v112, v86
  v_mul_f32 v113, v113, v87
  v_exp_f32 v110, v110
  v_exp_f32 v111, v111
  v_exp_f32 v112, v112
  v_exp_f32 v113, v113
  v_add_f32 v110, 1.0, v110
  v_add_f32 v111, 1.0, v111
  v_add_f32 v112, 1.0, v112
  v_add_f32 v113, 1.0, v113
  v_rcp_f32 v110, v110
  v_rcp_f32 v111, v111
  v_rcp_f32 v112, v112
  v_rcp_f32 v113, v113
  v_mul_f32 v84, v84, v110
  v_mul_f32 v85, v85, v111
  v_mul_f32 v86, v86, v112
  v_mul_f32 v87, v87, v113
  v_cvt_pk_bf16_f32 v82, v84, v85
  v_cvt_pk_bf16_f32 v83, v86, v87
  buffer_store_dwordx4 v[80:83], v127, s[20:23], s86 offen sc1
  v_mul_f32 v110, v88, v88
  v_mul_f32 v111, v89, v89
  v_mul_f32 v112, v90, v90
  v_mul_f32 v113, v91, v91
  v_fma_f32 v110, v110, v23, v22
  v_fma_f32 v111, v111, v23, v22
  v_fma_f32 v112, v112, v23, v22
  v_fma_f32 v113, v113, v23, v22
  v_mul_f32 v110, v110, v88
  v_mul_f32 v111, v111, v89
  v_mul_f32 v112, v112, v90
  v_mul_f32 v113, v113, v91
  v_exp_f32 v110, v110
  v_exp_f32 v111, v111
  v_exp_f32 v112, v112
  v_exp_f32 v113, v113
  v_add_f32 v110, 1.0, v110
  v_add_f32 v111, 1.0, v111
  v_add_f32 v112, 1.0, v112
  v_add_f32 v113, 1.0, v113
  s_mov_b32 exec_lo, 0xffffffff
  s_mov_b32 exec_hi, 0xff
  buffer_load_dword v253, v254, s[20:23], s65 offen sc1
  s_mov_b64 exec, -1
  v_rcp_f32 v110, v110
  v_rcp_f32 v111, v111
  v_rcp_f32 v112, v112
  v_rcp_f32 v113, v113
  v_mul_f32 v88, v88, v110
  v_mul_f32 v89, v89, v111
  v_mul_f32 v90, v90, v112
  v_mul_f32 v91, v91, v113
  v_cvt_pk_bf16_f32 v84, v88, v89
  v_cvt_pk_bf16_f32 v85, v90, v91
  v_mul_f32 v110, v92, v92
  v_mul_f32 v111, v93, v93
  v_mul_f32 v112, v94, v94
  v_mul_f32 v113, v95, v95
  v_fma_f32 v110, v110, v23, v22
  v_fma_f32 v111, v111, v23, v22
  v_fma_f32 v112, v112, v23, v22
  v_fma_f32 v113, v113, v23, v22
  v_mul_f32 v110, v110, v92
  v_mul_f32 v111, v111, v93
  v_mul_f32 v112, v112, v94
  v_mul_f32 v113, v113, v95
  v_exp_f32 v110, v110
  v_exp_f32 v111, v111
  v_exp_f32 v112, v112
  v_exp_f32 v113, v113
  v_add_f32 v110, 1.0, v110
  v_add_f32 v111, 1.0, v111
  v_add_f32 v112, 1.0, v112
  v_add_f32 v113, 1.0, v113
  v_rcp_f32 v110, v110
  v_rcp_f32 v111, v111
  v_rcp_f32 v112, v112
  v_rcp_f32 v113, v113
  v_mul_f32 v92, v92, v110
  v_mul_f32 v93, v93, v111
  v_mul_f32 v94, v94, v112
  v_mul_f32 v95, v95, v113
  v_cvt_pk_bf16_f32 v86, v92, v93
  v_cvt_pk_bf16_f32 v87, v94, v95
  buffer_store_dwordx4 v[84:87], v127, s[20:23], s86 offen offset:1024 sc1
  s_waitcnt vmcnt(1)
  s_mov_b32 s59, 200000
L_spin_23:
  s_mov_b32 exec_lo, 0xffffffff
  s_mov_b32 exec_hi, 0xff
  v_cmp_ne_u32 vcc, 1, v253
  s_mov_b64 exec, -1
  s_nop 3
  s_cbranch_vccz L_ok_24
  s_sub_u32 s59, s59, 1
  s_cmp_eq_u32 s59, 0
  s_cbranch_scc1 L_ok_24
  s_mov_b32 exec_lo, 0xffffffff
  s_mov_b32 exec_hi, 0xff
    buffer_load_dword v253, v254, s[20:23], s65 offen sc1
  s_mov_b64 exec, -1
    s_waitcnt vmcnt(0)
  s_sleep 1
  s_branch L_spin_23
L_ok_24:
  s_cmp_eq_u32 s93, 0
  s_cselect_b32 s99, 0x40000000, 0
  v_add_u32 v242, s99, v252
  s_lshl_b32 s99, s93, 3
  s_sub_u32 s99, s99, 8
  s_add_u32 s100, s92, 32
  s_lshl_b32 s100, s100, 6
  s_add_u32 s100, s100, s99
  s_lshl_b32 s100, s100, 10
  s_add_u32 s52, s100, 2097152
  s_mov_b32 m0, 114688
  s_add_u32 s53, s100, 0
  buffer_load_dwordx4 v242, s[20:23], s53 offen offset:0 sc1 lds
  buffer_load_dwordx4 v242, s[20:23], s53 offen offset:1024 sc1 lds
  buffer_load_dwordx4 v242, s[20:23], s53 offen offset:2048 sc1 lds
  buffer_load_dwordx4 v242, s[20:23], s53 offen offset:3072 sc1 lds
  s_mov_b32 m0, 118784
  s_add_u32 s53, s100, 4096
  buffer_load_dwordx4 v242, s[20:23], s53 offen offset:0 sc1 lds
  buffer_load_dwordx4 v242, s[20:23], s53 offen offset:1024 sc1 lds
  buffer_load_dwordx4 v242, s[20:23], s53 offen offset:2048 sc1 lds
  buffer_load_dwordx4 v242, s[20:23], s53 offen offset:3072 sc1 lds
  s_mov_b32 m0, 122880
  s_add_u32 s53, s100, 8192
  buffer_load_dwordx4 v252, s[20:23], s53 offen offset:0 sc1 lds
  buffer_load_dwordx4 v252, s[20:23], s53 offen offset:1024 sc1 lds
  buffer_load_dwordx4 v252, s[20:23], s53 offen offset:2048 sc1 lds
  buffer_load_dwordx4 v252, s[20:23], s53 offen offset:3072 sc1 lds
  s_mov_b32 m0, 126976
  s_add_u32 s53, s100, 12288
  buffer_load_dwordx4 v252, s[20:23], s53 offen offset:0 sc1 lds
  buffer_load_dwordx4 v252, s[20:23], s53 offen offset:1024 sc1 lds
  buffer_load_dwordx4 v252, s[20:23], s53 offen offset:2048 sc1 lds
  buffer_load_dwordx4 v252, s[20:23], s53 offen offset:3072 sc1 lds
  s_lshl_b32 s99, s92, 6
  s_lshl_b32 s100, s93, 3
  s_add_u32 s99, s99, s100
  s_lshl_b32 s100, s99, 10
  s_mov_b32 m0, 148480
  s_add_u32 s53, s100, 0
  buffer_load_dwordx4 v252, s[20:23], s53 offen offset:0 sc1 lds
  buffer_load_dwordx4 v252, s[20:23], s53 offen offset:1024 sc1 lds
  buffer_load_dwordx4 v252, s[20:23], s53 offen offset:2048 sc1 lds
  buffer_load_dwordx4 v252, s[20:23], s53 offen offset:3072 sc1 lds
  s_mov_b32 m0, 152576
  s_add_u32 s53, s100, 4096
  buffer_load_dwordx4 v252, s[20:23], s53 offen offset:0 sc1 lds
  buffer_load_dwordx4 v252, s[20:23], s53 offen offset:1024 sc1 lds
  buffer_load_dwordx4 v252, s[20:23], s53 offen offset:2048 sc1 lds
  buffer_load_dwordx4 v252, s[20:23], s53 offen offset:3072 sc1 lds
  s_mov_b32 m0, 131072
  s_add_u32 s53, s52, 0
  buffer_load_dwordx4 v242, s[20:23], s53 offen sc1 lds
  s_mov_b32 m0, 132160
  s_add_u32 s53, s52, 1024
  buffer_load_dwordx4 v242, s[20:23], s53 offen sc1 lds
  s_mov_b32 m0, 133248
  s_add_u32 s53, s52, 2048
  buffer_load_dwordx4 v242, s[20:23], s53 offen sc1 lds
  s_mov_b32 m0, 134336
  s_add_u32 s53, s52, 3072
  buffer_load_dwordx4 v242, s[20:23], s53 offen sc1 lds
  s_mov_b32 m0, 135424
  s_add_u32 s53, s52, 4096
  buffer_load_dwordx4 v242, s[20:23], s53 offen sc1 lds
  s_mov_b32 m0, 136512
  s_add_u32 s53, s52, 5120
  buffer_load_dwordx4 v242, s[20:23], s53 offen sc1 lds
  s_mov_b32 m0, 137600
  s_add_u32 s53, s52, 6144
  buffer_load_dwordx4 v242, s[20:23], s53 offen sc1 lds
  s_mov_b32 m0, 138688
  s_add_u32 s53, s52, 7168
  buffer_load_dwordx4 v242, s[20:23], s53 offen sc1 lds
  s_mov_b32 m0, 139776
  s_add_u32 s53, s52, 8192
  buffer_load_dwordx4 v252, s[20:23], s53 offen sc1 lds
  s_mov_b32 m0, 140864
  s_add_u32 s53, s52, 9216
  buffer_load_dwordx4 v252, s[20:23], s53 offen sc1 lds
  s_mov_b32 m0, 141952
  s_add_u32 s53, s52, 10240
  buffer_load_dwordx4 v252, s[20:23], s53 offen sc1 lds
  s_mov_b32 m0, 143040
  s_add_u32 s53, s52, 11264
  buffer_load_dwordx4 v252, s[20:23], s53 offen sc1 lds
  s_mov_b32 m0, 144128
  s_add_u32 s53, s52, 12288
  buffer_load_dwordx4 v252, s[20:23], s53 offen sc1 lds
  s_mov_b32 m0, 145216
  s_add_u32 s53, s52, 13312
  buffer_load_dwordx4 v252, s[20:23], s53 offen sc1 lds
  s_mov_b32 m0, 146304
  s_add_u32 s53, s52, 14336
  buffer_load_dwordx4 v252, s[20:23], s53 offen sc1 lds
  s_mov_b32 m0, 147392
  s_add_u32 s53, s52, 15360
  buffer_load_dwordx4 v252, s[20:23], s53 offen sc1 lds
  s_setprio 0
  s_mov_b32 s72, 0
  v_lshrrev_b32 v242, 2, v1
  v_and_b32 v243, 3, v1
  v_mul_u32_u24 v244, 1088, v242
  v_lshl_add_u32 v244, v243, 3, v244
  v_add_u32 v244, 132096, v244
  s_cmp_eq_u32 s93, 0
  s_cselect_b32 s99, 8, 0
  v_cmp_le_u32 vcc, s99, v242
  v_mov_b32 v246, 0x3f80
  s_nop 0
  v_cndmask_b32 v246, 0, v246, vcc
  v_cmp_gt_u32 vcc, 2, v243
  s_nop 1
  v_cndmask_b32 v246, 0, v246, vcc
  v_mov_b32 v247, 0
  ds_write_b64 v244, v[246:247]
  v_mov_b32 v244, 156736
  ds_write_b32 v244, v247
  s_lshl_b32 s99, s42, 10
  s_add_u32 s100, s99, 114688
  v_add_u32 v236, s100, v252
  s_add_u32 s100, s99, 148480
  v_add_u32 v241, s100, v252
  v_bfe_u32 v242, v1, 1, 1
  v_lshlrev_b32 v242, 3, v242
  v_bfe_u32 v243, v1, 2, 2
  v_lshl_or_b32 v242, v243, 4, v242
  v_lshrrev_b32 v244, 5, v1
  v_lshl_or_b32 v242, v244, 6, v242
  v_and_b32 v243, 1, v1
  v_lshl_or_b32 v242, v243, 9, v242
  v_and_b32 v243, 3, v1
  v_lshlrev_b32 v243, 3, v243
  v_or_b32 v243, 0x400, v243
  v_and_b32 v245, 16, v1
  v_cmp_eq_u32 vcc, 0, v245
  s_mul_i32 s99, s42, 1088
  s_add_u32 s99, s99, 131072
  v_mov_b32 v245, 0x80
  v_cndmask_b32 v242, v243, v242, vcc
  v_cndmask_b32 v245, 0, v245, vcc
  v_add_u32 v237, s99, v242
  v_add_u32 v238, v237, v245
  v_add_u32 v239, v238, v245
  v_add_u32 v240, v239, v245
  v_and_b32 v242, 31, v1
  v_lshlrev_b32 v244, 2, v244
  v_sub_u32 v242, v242, v244
  v_mov_b32 v243, 0xf149f2ca
  v_cmp_gt_i32 s[52:53], 0, v242
  v_cmp_gt_i32 s[54:55], 1, v242
  v_cmp_gt_i32 s[56:57], 2, v242
  v_cmp_gt_i32 s[58:59], 3, v242
  v_cndmask_b32 v204, v243, 0, s[52:53]
  v_cndmask_b32 v220, 0, v243, s[52:53]
  v_cndmask_b32 v205, v243, 0, s[54:55]
  v_cndmask_b32 v221, 0, v243, s[54:55]
  v_cndmask_b32 v206, v243, 0, s[56:57]
  v_cndmask_b32 v222, 0, v243, s[56:57]
  v_cndmask_b32 v207, v243, 0, s[58:59]
  v_cndmask_b32 v223, 0, v243, s[58:59]
  v_cmp_gt_i32 s[52:53], 8, v242
  v_cmp_gt_i32 s[54:55], 9, v242
  v_cmp_gt_i32 s[56:57], 10, v242
  v_cmp_gt_i32 s[58:59], 11, v242
  v_cndmask_b32 v208, v243, 0, s[52:53]
  v_cndmask_b32 v224, 0, v243, s[52:53]
  v_cndmask_b32 v209, v243, 0, s[54:55]
  v_cndmask_b32 v225, 0, v243, s[54:55]
  v_cndmask_b32 v210, v243, 0, s[56:57]
  v_cndmask_b32 v226, 0, v243, s[56:57]
  v_cndmask_b32 v211, v243, 0, s[58:59]
  v_cndmask_b32 v227, 0, v243, s[58:59]
  v_cmp_gt_i32 s[52:53], 16, v242
  v_cmp_gt_i32 s[54:55], 17, v242
  v_cmp_gt_i32 s[56:57], 18, v242
  v_cmp_gt_i32 s[58:59], 19, v242
  v_cndmask_b32 v212, v243, 0, s[52:53]
  v_cndmask_b32 v228, 0, v243, s[52:53]
  v_cndmask_b32 v213, v243, 0, s[54:55]
  v_cndmask_b32 v229, 0, v243, s[54:55]
  v_cndmask_b32 v214, v243, 0, s[56:57]
  v_cndmask_b32 v230, 0, v243, s[56:57]
  v_cndmask_b32 v215, v243, 0, s[58:59]
  v_cndmask_b32 v231, 0, v243, s[58:59]
  v_cmp_gt_i32 s[52:53], 24, v242
  v_cmp_gt_i32 s[54:55], 25, v242
  v_cmp_gt_i32 s[56:57], 26, v242
  v_cmp_gt_i32 s[58:59], 27, v242
  v_cndmask_b32 v216, v243, 0, s[52:53]
  v_cndmask_b32 v232, 0, v243, s[52:53]
  v_cndmask_b32 v217, v243, 0, s[54:55]
  v_cndmask_b32 v233, 0, v243, s[54:55]
  v_cndmask_b32 v218, v243, 0, s[56:57]
  v_cndmask_b32 v234, 0, v243, s[56:57]
  v_cndmask_b32 v219, v243, 0, s[58:59]
  v_cndmask_b32 v235, 0, v243, s[58:59]
  s_waitcnt lgkmcnt(0)
  s_nop 0
  s_branch L_passC_done_20
L_plain_22:
  v_mul_f32 v110, v80, v80
  v_mul_f32 v111, v81, v81
  v_mul_f32 v112, v82, v82
  v_mul_f32 v113, v83, v83
  v_fma_f32 v110, v110, v23, v22
  v_fma_f32 v111, v111, v23, v22
  v_fma_f32 v112, v112, v23, v22
  v_fma_f32 v113, v113, v23, v22
  v_mul_f32 v110, v110, v80
  v_mul_f32 v111, v111, v81
  v_mul_f32 v112, v112, v82
  v_mul_f32 v113, v113, v83
  v_exp_f32 v110, v110
  v_exp_f32 v111, v111
  v_exp_f32 v112, v112
  v_exp_f32 v113, v113
  v_add_f32 v110, 1.0, v110
  v_add_f32 v111, 1.0, v111
  v_add_f32 v112, 1.0, v112
  v_add_f32 v113, 1.0, v113
  v_rcp_f32 v110, v110
  v_rcp_f32 v111, v111
  v_rcp_f32 v112, v112
  v_rcp_f32 v113, v113
  v_mul_f32 v80, v80, v110
  v_mul_f32 v81, v81, v111
  v_mul_f32 v82, v82, v112
  v_mul_f32 v83, v83, v113
  v_cvt_pk_bf16_f32 v80, v80, v81
  v_cvt_pk_bf16_f32 v81, v82, v83
  v_mul_f32 v110, v84, v84
  v_mul_f32 v111, v85, v85
  v_mul_f32 v112, v86, v86
  v_mul_f32 v113, v87, v87
  v_fma_f32 v110, v110, v23, v22
  v_fma_f32 v111, v111, v23, v22
  v_fma_f32 v112, v112, v23, v22
  v_fma_f32 v113, v113, v23, v22
  v_mul_f32 v110, v110, v84
  v_mul_f32 v111, v111, v85
  v_mul_f32 v112, v112, v86
  v_mul_f32 v113, v113, v87
  v_exp_f32 v110, v110
  v_exp_f32 v111, v111
  v_exp_f32 v112, v112
  v_exp_f32 v113, v113
  v_add_f32 v110, 1.0, v110
  v_add_f32 v111, 1.0, v111
  v_add_f32 v112, 1.0, v112
  v_add_f32 v113, 1.0, v113
  v_rcp_f32 v110, v110
  v_rcp_f32 v111, v111
  v_rcp_f32 v112, v112
  v_rcp_f32 v113, v113
  v_mul_f32 v84, v84, v110
  v_mul_f32 v85, v85, v111
  v_mul_f32 v86, v86, v112
  v_mul_f32 v87, v87, v113
  v_cvt_pk_bf16_f32 v82, v84, v85
  v_cvt_pk_bf16_f32 v83, v86, v87
  buffer_store_dwordx4 v[80:83], v127, s[20:23], s86 offen sc1
  v_mul_f32 v110, v88, v88
  v_mul_f32 v111, v89, v89
  v_mul_f32 v112, v90, v90
  v_mul_f32 v113, v91, v91
  v_fma_f32 v110, v110, v23, v22
  v_fma_f32 v111, v111, v23, v22
  v_fma_f32 v112, v112, v23, v22
  v_fma_f32 v113, v113, v23, v22
  v_mul_f32 v110, v110, v88
  v_mul_f32 v111, v111, v89
  v_mul_f32 v112, v112, v90
  v_mul_f32 v113, v113, v91
  v_exp_f32 v110, v110
  v_exp_f32 v111, v111
  v_exp_f32 v112, v112
  v_exp_f32 v113, v113
  v_add_f32 v110, 1.0, v110
  v_add_f32 v111, 1.0, v111
  v_add_f32 v112, 1.0, v112
  v_add_f32 v113, 1.0, v113
  v_rcp_f32 v110, v110
  v_rcp_f32 v111, v111
  v_rcp_f32 v112, v112
  v_rcp_f32 v113, v113
  v_mul_f32 v88, v88, v110
  v_mul_f32 v89, v89, v111
  v_mul_f32 v90, v90, v112
  v_mul_f32 v91, v91, v113
  v_cvt_pk_bf16_f32 v84, v88, v89
  v_cvt_pk_bf16_f32 v85, v90, v91
  v_mul_f32 v110, v92, v92
  v_mul_f32 v111, v93, v93
  v_mul_f32 v112, v94, v94
  v_mul_f32 v113, v95, v95
  v_fma_f32 v110, v110, v23, v22
  v_fma_f32 v111, v111, v23, v22
  v_fma_f32 v112, v112, v23, v22
  v_fma_f32 v113, v113, v23, v22
  v_mul_f32 v110, v110, v92
  v_mul_f32 v111, v111, v93
  v_mul_f32 v112, v112, v94
  v_mul_f32 v113, v113, v95
  v_exp_f32 v110, v110
  v_exp_f32 v111, v111
  v_exp_f32 v112, v112
  v_exp_f32 v113, v113
  v_add_f32 v110, 1.0, v110
  v_add_f32 v111, 1.0, v111
  v_add_f32 v112, 1.0, v112
  v_add_f32 v113, 1.0, v113
  v_rcp_f32 v110, v110
  v_rcp_f32 v111, v111
  v_rcp_f32 v112, v112
  v_rcp_f32 v113, v113
  v_mul_f32 v92, v92, v110
  v_mul_f32 v93, v93, v111
  v_mul_f32 v94, v94, v112
  v_mul_f32 v95, v95, v113
  v_cvt_pk_bf16_f32 v86, v92, v93
  v_cvt_pk_bf16_f32 v87, v94, v95
  buffer_store_dwordx4 v[84:87], v127, s[20:23], s86 offen offset:1024 sc1
  v_lshlrev_b32 v252, 4, v1
  s_mov_b32 s72, 0
  v_lshrrev_b32 v242, 2, v1
  v_and_b32 v243, 3, v1
  v_mul_u32_u24 v244, 1088, v242
  v_lshl_add_u32 v244, v243, 3, v244
  v_add_u32 v244, 132096, v244
  s_cmp_eq_u32 s93, 0
  s_cselect_b32 s99, 8, 0
  v_cmp_le_u32 vcc, s99, v242
  v_mov_b32 v246, 0x3f80
  s_nop 0
  v_cndmask_b32 v246, 0, v246, vcc
  v_cmp_gt_u32 vcc, 2, v243
  s_nop 1
  v_cndmask_b32 v246, 0, v246, vcc
  v_mov_b32 v247, 0
  ds_write_b64 v244, v[246:247]
  v_mov_b32 v244, 156736
  ds_write_b32 v244, v247
  s_lshl_b32 s99, s42, 10
  s_add_u32 s100, s99, 114688
  v_add_u32 v236, s100, v252
  s_add_u32 s100, s99, 148480
  v_add_u32 v241, s100, v252
  v_bfe_u32 v242, v1, 1, 1
  v_lshlrev_b32 v242, 3, v242
  v_bfe_u32 v243, v1, 2, 2
  v_lshl_or_b32 v242, v243, 4, v242
  v_lshrrev_b32 v244, 5, v1
  v_lshl_or_b32 v242, v244, 6, v242
  v_and_b32 v243, 1, v1
  v_lshl_or_b32 v242, v243, 9, v242
  v_and_b32 v243, 3, v1
  v_lshlrev_b32 v243, 3, v243
  v_or_b32 v243, 0x400, v243
  v_and_b32 v245, 16, v1
  v_cmp_eq_u32 vcc, 0, v245
  s_mul_i32 s99, s42, 1088
  s_add_u32 s99, s99, 131072
  v_mov_b32 v245, 0x80
  v_cndmask_b32 v242, v243, v242, vcc
  v_cndmask_b32 v245, 0, v245, vcc
  v_add_u32 v237, s99, v242
  v_add_u32 v238, v237, v245
  v_add_u32 v239, v238, v245
  v_add_u32 v240, v239, v245
  v_and_b32 v242, 31, v1
  v_lshlrev_b32 v244, 2, v244
  v_sub_u32 v242, v242, v244
  v_mov_b32 v243, 0xf149f2ca
  v_cmp_gt_i32 s[52:53], 0, v242
  v_cmp_gt_i32 s[54:55], 1, v242
  v_cmp_gt_i32 s[56:57], 2, v242
  v_cmp_gt_i32 s[58:59], 3, v242
  v_cndmask_b32 v204, v243, 0, s[52:53]
  v_cndmask_b32 v220, 0, v243, s[52:53]
  v_cndmask_b32 v205, v243, 0, s[54:55]
  v_cndmask_b32 v221, 0, v243, s[54:55]
  v_cndmask_b32 v206, v243, 0, s[56:57]
  v_cndmask_b32 v222, 0, v243, s[56:57]
  v_cndmask_b32 v207, v243, 0, s[58:59]
  v_cndmask_b32 v223, 0, v243, s[58:59]
  v_cmp_gt_i32 s[52:53], 8, v242
  v_cmp_gt_i32 s[54:55], 9, v242
  v_cmp_gt_i32 s[56:57], 10, v242
  v_cmp_gt_i32 s[58:59], 11, v242
  v_cndmask_b32 v208, v243, 0, s[52:53]
  v_cndmask_b32 v224, 0, v243, s[52:53]
  v_cndmask_b32 v209, v243, 0, s[54:55]
  v_cndmask_b32 v225, 0, v243, s[54:55]
  v_cndmask_b32 v210, v243, 0, s[56:57]
  v_cndmask_b32 v226, 0, v243, s[56:57]
  v_cndmask_b32 v211, v243, 0, s[58:59]
  v_cndmask_b32 v227, 0, v243, s[58:59]
  v_cmp_gt_i32 s[52:53], 16, v242
  v_cmp_gt_i32 s[54:55], 17, v242
  v_cmp_gt_i32 s[56:57], 18, v242
  v_cmp_gt_i32 s[58:59], 19, v242
  v_cndmask_b32 v212, v243, 0, s[52:53]
  v_cndmask_b32 v228, 0, v243, s[52:53]
  v_cndmask_b32 v213, v243, 0, s[54:55]
  v_cndmask_b32 v229, 0, v243, s[54:55]
  v_cndmask_b32 v214, v243, 0, s[56:57]
  v_cndmask_b32 v230, 0, v243, s[56:57]
  v_cndmask_b32 v215, v243, 0, s[58:59]
  v_cndmask_b32 v231, 0, v243, s[58:59]
  v_cmp_gt_i32 s[52:53], 24, v242
  v_cmp_gt_i32 s[54:55], 25, v242
  v_cmp_gt_i32 s[56:57], 26, v242
  v_cmp_gt_i32 s[58:59], 27, v242
  v_cndmask_b32 v216, v243, 0, s[52:53]
  v_cndmask_b32 v232, 0, v243, s[52:53]
  v_cndmask_b32 v217, v243, 0, s[54:55]
  v_cndmask_b32 v233, 0, v243, s[54:55]
  v_cndmask_b32 v218, v243, 0, s[56:57]
  v_cndmask_b32 v234, 0, v243, s[56:57]
  v_cndmask_b32 v219, v243, 0, s[58:59]
  v_cndmask_b32 v235, 0, v243, s[58:59]
  s_waitcnt vmcnt(2)
  s_waitcnt lgkmcnt(0)
L_passC_done_20:
  s_barrier
  v_mov_b32 v6, v18
  s_bfe_u32 s99, s42, 0x10001
  v_and_b32 v242, 3, v1
  v_lshlrev_b32 v242, 3, v242
  v_bfe_u32 v243, v1, 4, 1
  v_lshl_or_b32 v242, v243, 5, v242
  v_bfe_u32 v243, v1, 3, 1
  v_xor_b32 v243, s99, v243
  v_lshl_or_b32 v242, v243, 6, v242
  v_bfe_u32 v243, v1, 2, 2
  v_lshl_or_b32 v242, v243, 7, v242
  v_lshrrev_b32 v243, 5, v1
  v_lshl_or_b32 v2, v243, 9, v242
  s_lshr_b32 s100, s42, 2
  s_lshl_b32 s100, s100, 13
  v_add_u32 v2, s100, v2
  v_add_u32 v3, 65536, v2
  v_add_u32 v4, 98304, v2
  ds_read_b64_tr_b16 v[8:9], v2 offset:32768
  ds_read_b64_tr_b16 v[10:11], v2 offset:33792
  ds_read_b64_tr_b16 v[12:13], v2 offset:34816
  ds_read_b64_tr_b16 v[14:15], v2 offset:35840
  ds_read_b64_tr_b16 v[16:17], v2 offset:36864
  s_cmp_ge_u32 s70, 10
  s_cselect_b32 s71, 917504, 0
  s_sub_u32 s71, s60, s71
  s_add_u32 s71, s71, 262144
  s_add_u32 m0, s64, 81920
  s_mov_b32 s57, s71
  buffer_load_dwordx4 v6, s[24:27], s57 offen lds
  ds_read_b64_tr_b16 v[18:19], v2 offset:37888
  ds_read_b64_tr_b16 v[20:21], v2 offset:38912
  ds_read_b64_tr_b16 v[22:23], v2 offset:39936
  ds_read_b64_tr_b16 v[24:25], v2 offset:49152
  ds_read_b64_tr_b16 v[26:27], v2 offset:50176
  s_add_u32 m0, s64, 82944
  s_add_u32 s57, s71, 8192
  buffer_load_dwordx4 v6, s[24:27], s57 offen lds
  ds_read_b64_tr_b16 v[28:29], v2 offset:51200
  ds_read_b64_tr_b16 v[30:31], v2 offset:52224
  ds_read_b64_tr_b16 v[32:33], v2 offset:53248
  ds_read_b64_tr_b16 v[34:35], v2 offset:54272
  ds_read_b64_tr_b16 v[36:37], v2 offset:55296
  s_cmp_ge_u32 s70, 9
  s_cselect_b32 s71, 917504, 0
  s_sub_u32 s71, s60, s71
  s_add_u32 s71, s71, 327680
  s_add_u32 m0, s64, 0
  s_mov_b32 s57, s71
  buffer_load_dwordx4 v6, s[24:27], s57 offen lds
  ds_read_b64_tr_b16 v[38:39], v2 offset:56320
  ds_read_b64_tr_b16 v[40:41], v3 offset:0
  ds_read_b64_tr_b16 v[42:43], v3 offset:1024
  ds_read_b64_tr_b16 v[44:45], v3 offset:2048
  ds_read_b64_tr_b16 v[46:47], v3 offset:3072
  s_add_u32 m0, s64, 1024
  s_add_u32 s57, s71, 8192
  buffer_load_dwordx4 v6, s[24:27], s57 offen lds
  ds_read_b64_tr_b16 v[48:49], v3 offset:4096
  ds_read_b64_tr_b16 v[50:51], v3 offset:5120
  ds_read_b64_tr_b16 v[52:53], v3 offset:6144
  ds_read_b64_tr_b16 v[54:55], v3 offset:7168
  ds_read_b64_tr_b16 v[56:57], v4 offset:0
  s_cmp_ge_u32 s70, 8
  s_cselect_b32 s71, 917504, 0
  s_sub_u32 s71, s60, s71
  s_add_u32 s71, s71, 393216
  s_add_u32 m0, s64, 16384
  s_mov_b32 s57, s71
  buffer_load_dwordx4 v6, s[24:27], s57 offen lds
  ds_read_b64_tr_b16 v[58:59], v4 offset:1024
  ds_read_b64_tr_b16 v[60:61], v4 offset:2048
  ds_read_b64_tr_b16 v[62:63], v4 offset:3072
  ds_read_b64_tr_b16 v[64:65], v4 offset:4096
  ds_read_b64_tr_b16 v[66:67], v4 offset:5120
  s_add_u32 m0, s64, 17408
  s_add_u32 s57, s71, 8192
  buffer_load_dwordx4 v6, s[24:27], s57 offen lds
  ds_read_b64_tr_b16 v[68:69], v4 offset:6144
  ds_read_b64_tr_b16 v[70:71], v4 offset:7168
  s_lshl2_add_u32 s99, s45, s43
  s_lshl_b32 s99, s99, 5
  s_lshl2_add_u32 s100, s46, s47
  s_lshl1_add_u32 s100, s100, s44
  s_add_u32 s99, s99, s100
  s_lshl_b32 s99, s99, 2
  s_add_u32 s99, s99, 15740928
  s_waitcnt vmcnt(6)
  v_mov_b32 v254, 0
  v_mov_b32 v253, 1
  s_mov_b64 exec, 0x1
  buffer_store_dword v253, v254, s[20:23], s99 offen sc1
  s_mov_b64 exec, -1
  s_waitcnt lgkmcnt(0)
  s_barrier
  ds_read_b128 v[128:131], v241
  ds_read_b128 v[132:135], v236 offset:0
  ds_read_b128 v[136:139], v236 offset:1024
  ds_read_b64_tr_b16 v[140:141], v237 offset:0
  ds_read_b64_tr_b16 v[142:143], v238 offset:0
  ds_read_b64_tr_b16 v[144:145], v239 offset:0
  ds_read_b64_tr_b16 v[146:147], v240 offset:0
  s_waitcnt lgkmcnt(5)
  v_mfma_f32_32x32x16_bf16 v[156:171], v[132:135], v[128:131], v[204:219]
  s_waitcnt lgkmcnt(4)
  v_mfma_f32_32x32x16_bf16 v[172:187], v[136:139], v[128:131], 0
  ds_read_b128 v[132:135], v236 offset:2048
  ds_read_b64_tr_b16 v[148:149], v237 offset:1088
  ds_read_b64_tr_b16 v[150:151], v238 offset:1088
  ds_read_b64_tr_b16 v[152:153], v239 offset:1088
  ds_read_b64_tr_b16 v[154:155], v240 offset:1088
  s_nop 4
  v_exp_f32 v156, v156
  v_exp_f32 v157, v157
  v_exp_f32 v158, v158
  v_exp_f32 v159, v159
  v_exp_f32 v160, v160
  v_exp_f32 v161, v161
  v_exp_f32 v162, v162
  v_exp_f32 v163, v163
  s_cmp_ge_u32 s70, 6
  s_cselect_b32 s71, 917504, 0
  s_sub_u32 s71, s60, s71
  s_add_u32 s71, s71, 524288
  s_add_u32 m0, s64, 32768
  s_mov_b32 s57, s71
  buffer_load_dwordx4 v6, s[24:27], s57 offen lds
  s_add_u32 m0, s64, 33792
  s_add_u32 s57, s71, 8192
  buffer_load_dwordx4 v6, s[24:27], s57 offen lds
  v_cvt_pk_bf16_f32 v156, v156, v157
  v_cvt_pk_bf16_f32 v157, v158, v159
  v_cvt_pk_bf16_f32 v158, v160, v161
  v_cvt_pk_bf16_f32 v159, v162, v163
  v_exp_f32 v164, v164
  v_exp_f32 v165, v165
  v_exp_f32 v166, v166
  v_exp_f32 v167, v167
  s_cmp_ge_u32 s70, 5
  s_cselect_b32 s71, 917504, 0
  s_sub_u32 s71, s60, s71
  s_add_u32 s71, s71, 589824
  s_add_u32 m0, s64, 49152
  s_mov_b32 s57, s71
  buffer_load_dwordx4 v6, s[24:27], s57 offen lds
  s_add_u32 m0, s64, 50176
  s_add_u32 s57, s71, 8192
  buffer_load_dwordx4 v6, s[24:27], s57 offen lds
  s_waitcnt lgkmcnt(7)
  v_mfma_f32_32x32x16_bf16 v[188:203], v[140:143], v[156:159], 0
  v_exp_f32 v168, v168
  v_exp_f32 v169, v169
  v_exp_f32 v170, v170
  v_exp_f32 v171, v171
  v_cvt_pk_bf16_f32 v160, v164, v165
  v_cvt_pk_bf16_f32 v161, v166, v167
  v_cvt_pk_bf16_f32 v162, v168, v169
  v_cvt_pk_bf16_f32 v163, v170, v171
  s_waitcnt lgkmcnt(5)
  s_nop 0
  v_mfma_f32_32x32x16_bf16 v[188:203], v[144:147], v[160:163], v[188:203]
  s_cmp_lg_u32 s42, 7
  s_cbranch_scc1 L_ow_25
    s_lshr_b32 s58, s89, 3
    s_lshl_b32 s58, s58, 17
    s_lshl_b32 s59, s95, 7
    s_add_u32 s58, s58, s59
    v_lshlrev_b32 v250, 10, v1
    buffer_load_dword v251, v250, s[28:31], s58 offen
    s_add_u32 s58, s58, 65536
    buffer_load_dword v251, v250, s[28:31], s58 offen
L_ow_25:
  s_waitcnt lgkmcnt(4)
  v_mfma_f32_32x32x16_bf16 v[156:171], v[132:135], v[128:131], 0
  ds_read_b128 v[136:139], v236 offset:3072
  ds_read_b64_tr_b16 v[140:141], v237 offset:2176
  ds_read_b64_tr_b16 v[142:143], v238 offset:2176
  ds_read_b64_tr_b16 v[144:145], v239 offset:2176
  ds_read_b64_tr_b16 v[146:147], v240 offset:2176
  v_exp_f32 v172, v172
  v_exp_f32 v173, v173
  v_exp_f32 v174, v174
  v_exp_f32 v175, v175
  v_exp_f32 v176, v176
  v_exp_f32 v177, v177
  v_exp_f32 v178, v178
  v_exp_f32 v179, v179
  s_cmp_ge_u32 s70, 4
  s_cselect_b32 s71, 917504, 0
  s_sub_u32 s71, s60, s71
  s_add_u32 s71, s71, 655360
  s_add_u32 m0, s64, 65536
  s_mov_b32 s57, s71
  buffer_load_dwordx4 v6, s[24:27], s57 offen lds
  v_cvt_pk_bf16_f32 v172, v172, v173
  v_cvt_pk_bf16_f32 v173, v174, v175
  v_cvt_pk_bf16_f32 v174, v176, v177
  v_cvt_pk_bf16_f32 v175, v178, v179
  v_exp_f32 v180, v180
  v_exp_f32 v181, v181
  v_exp_f32 v182, v182
  v_exp_f32 v183, v183
  s_add_u32 m0, s64, 66560
  s_add_u32 s57, s71, 8192
  buffer_load_dwordx4 v6, s[24:27], s57 offen lds
  s_waitcnt lgkmcnt(7)
  v_mfma_f32_32x32x16_bf16 v[188:203], v[148:151], v[172:175], v[188:203]
  v_exp_f32 v184, v184
  v_exp_f32 v185, v185
  v_exp_f32 v186, v186
  v_exp_f32 v187, v187
  v_cvt_pk_bf16_f32 v176, v180, v181
  v_cvt_pk_bf16_f32 v177, v182, v183
  v_cvt_pk_bf16_f32 v178, v184, v185
  v_cvt_pk_bf16_f32 v179, v186, v187
  s_waitcnt lgkmcnt(5)
  s_nop 0
  v_mfma_f32_32x32x16_bf16 v[188:203], v[152:155], v[176:179], v[188:203]
  s_waitcnt lgkmcnt(0)
  s_waitcnt vmcnt(7)
  s_barrier
  v_mfma_f32_32x32x16_bf16 v[172:187], v[136:139], v[128:131], 0
  ds_read_b128 v[132:135], v236 offset:4096
  ds_read_b64_tr_b16 v[148:149], v237 offset:3264
  ds_read_b64_tr_b16 v[150:151], v238 offset:3264
  ds_read_b64_tr_b16 v[152:153], v239 offset:3264
  ds_read_b64_tr_b16 v[154:155], v240 offset:3264
  v_exp_f32 v156, v156
  v_exp_f32 v157, v157
  v_exp_f32 v158, v158
  v_exp_f32 v159, v159
  v_exp_f32 v160, v160
  v_exp_f32 v161, v161
  v_exp_f32 v162, v162
  v_exp_f32 v163, v163
  ds_read_b64_tr_b16 v[72:73], v3 offset:16384
  ds_read_b64_tr_b16 v[74:75], v3 offset:17408
  ds_read_b64_tr_b16 v[76:77], v3 offset:18432
  ds_read_b64_tr_b16 v[78:79], v3 offset:19456
  ds_read_b64_tr_b16 v[80:81], v3 offset:20480
  ds_read_b64_tr_b16 v[82:83], v3 offset:21504
  v_cvt_pk_bf16_f32 v156, v156, v157
  v_cvt_pk_bf16_f32 v157, v158, v159
  v_cvt_pk_bf16_f32 v158, v160, v161
  v_cvt_pk_bf16_f32 v159, v162, v163
  v_exp_f32 v164, v164
  v_exp_f32 v165, v165
  v_exp_f32 v166, v166
  v_exp_f32 v167, v167
  ds_read_b64_tr_b16 v[84:85], v3 offset:22528
  ds_read_b64_tr_b16 v[86:87], v3 offset:23552
  ds_read_b64_tr_b16 v[88:89], v2 offset:0
  ds_read_b64_tr_b16 v[90:91], v2 offset:1024
  ds_read_b64_tr_b16 v[92:93], v2 offset:2048
  ds_read_b64_tr_b16 v[94:95], v2 offset:3072
  v_mfma_f32_32x32x16_bf16 v[188:203], v[140:143], v[156:159], v[188:203]
  v_exp_f32 v168, v168
  v_exp_f32 v169, v169
  v_exp_f32 v170, v170
  v_exp_f32 v171, v171
  ds_read_b64_tr_b16 v[96:97], v2 offset:4096
  ds_read_b64_tr_b16 v[98:99], v2 offset:5120
  ds_read_b64_tr_b16 v[100:101], v2 offset:6144
  ds_read_b64_tr_b16 v[102:103], v2 offset:7168
  v_cvt_pk_bf16_f32 v160, v164, v165
  v_cvt_pk_bf16_f32 v161, v166, v167
  v_cvt_pk_bf16_f32 v162, v168, v169
  v_cvt_pk_bf16_f32 v163, v170, v171
  s_nop 1
  v_mfma_f32_32x32x16_bf16 v[188:203], v[144:147], v[160:163], v[188:203]
  s_waitcnt lgkmcnt(15)
  v_mfma_f32_32x32x16_bf16 v[156:171], v[132:135], v[128:131], 0
  ds_read_b128 v[136:139], v236 offset:5120
  ds_read_b64_tr_b16 v[140:141], v237 offset:4352
  ds_read_b64_tr_b16 v[142:143], v238 offset:4352
  ds_read_b64_tr_b16 v[144:145], v239 offset:4352
  ds_read_b64_tr_b16 v[146:147], v240 offset:4352
  v_exp_f32 v172, v172
  v_exp_f32 v173, v173
  v_exp_f32 v174, v174
  v_exp_f32 v175, v175
  v_exp_f32 v176, v176
  v_exp_f32 v177, v177
  v_exp_f32 v178, v178
  v_exp_f32 v179, v179
  ds_read_b64_tr_b16 v[104:105], v2 offset:16384
  ds_read_b64_tr_b16 v[106:107], v2 offset:17408
  ds_read_b64_tr_b16 v[108:109], v2 offset:18432
  v_cvt_pk_bf16_f32 v172, v172, v173
  v_cvt_pk_bf16_f32 v173, v174, v175
  v_cvt_pk_bf16_f32 v174, v176, v177
  v_cvt_pk_bf16_f32 v175, v178, v179
  v_exp_f32 v180, v180
  v_exp_f32 v181, v181
  v_exp_f32 v182, v182
  v_exp_f32 v183, v183
  ds_read_b64_tr_b16 v[110:111], v2 offset:19456
  ds_read_b64_tr_b16 v[112:113], v2 offset:20480
  ds_read_b64_tr_b16 v[114:115], v2 offset:21504
  s_waitcnt lgkmcnt(15)
  v_mfma_f32_32x32x16_bf16 v[188:203], v[148:151], v[172:175], v[188:203]
  v_exp_f32 v184, v184
  v_exp_f32 v185, v185
  v_exp_f32 v186, v186
  v_exp_f32 v187, v187
  ds_read_b64_tr_b16 v[116:117], v2 offset:22528
  ds_read_b64_tr_b16 v[118:119], v2 offset:23552
  v_cvt_pk_bf16_f32 v176, v180, v181
  v_cvt_pk_bf16_f32 v177, v182, v183
  v_cvt_pk_bf16_f32 v178, v184, v185
  v_cvt_pk_bf16_f32 v179, v186, v187
  s_waitcnt lgkmcnt(15)
  s_nop 0
  v_mfma_f32_32x32x16_bf16 v[188:203], v[152:155], v[176:179], v[188:203]
  s_waitcnt lgkmcnt(0)
  s_barrier
  v_mfma_f32_32x32x16_bf16 v[172:187], v[136:139], v[128:131], 0
  ds_read_b128 v[132:135], v236 offset:6144
  ds_read_b64_tr_b16 v[148:149], v237 offset:5440
  ds_read_b64_tr_b16 v[150:151], v238 offset:5440
  ds_read_b64_tr_b16 v[152:153], v239 offset:5440
  ds_read_b64_tr_b16 v[154:155], v240 offset:5440
  v_exp_f32 v156, v156
  v_exp_f32 v157, v157
  v_exp_f32 v158, v158
  v_exp_f32 v159, v159
  v_exp_f32 v160, v160
  v_exp_f32 v161, v161
  v_exp_f32 v162, v162
  v_exp_f32 v163, v163
  s_cmp_ge_u32 s70, 7
  s_cselect_b32 s71, 917504, 0
  s_sub_u32 s71, s60, s71
  s_add_u32 s71, s71, 458752
  s_add_u32 m0, s64, 81920
  s_mov_b32 s57, s71
  buffer_load_dwordx4 v6, s[24:27], s57 offen lds
  v_cvt_pk_bf16_f32 v156, v156, v157
  v_cvt_pk_bf16_f32 v157, v158, v159
  v_cvt_pk_bf16_f32 v158, v160, v161
  v_cvt_pk_bf16_f32 v159, v162, v163
  v_exp_f32 v164, v164
  v_exp_f32 v165, v165
  v_exp_f32 v166, v166
  v_exp_f32 v167, v167
  s_add_u32 m0, s64, 82944
  s_add_u32 s57, s71, 8192
  buffer_load_dwordx4 v6, s[24:27], s57 offen lds
  v_mfma_f32_32x32x16_bf16 v[188:203], v[140:143], v[156:159], v[188:203]
  v_exp_f32 v168, v168
  v_exp_f32 v169, v169
  v_exp_f32 v170, v170
  v_exp_f32 v171, v171
  v_cvt_pk_bf16_f32 v160, v164, v165
  v_cvt_pk_bf16_f32 v161, v166, v167
  v_cvt_pk_bf16_f32 v162, v168, v169
  v_cvt_pk_bf16_f32 v163, v170, v171
  s_nop 1
  v_mfma_f32_32x32x16_bf16 v[188:203], v[144:147], v[160:163], v[188:203]
  s_cmp_lg_u32 s42, 0
  s_cbranch_scc1 L_ow_26
  v_lshlrev_b32 v254, 2, v1
  s_lshl_b32 s99, s94, 8
  s_add_u32 s65, s99, 15740928
  s_mov_b64 exec, -1
  buffer_load_dword v253, v254, s[20:23], s65 offen sc1
  s_mov_b64 exec, -1
L_ow_26:
  s_waitcnt lgkmcnt(4)
  v_mfma_f32_32x32x16_bf16 v[156:171], v[132:135], v[128:131], 0
  ds_read_b128 v[136:139], v236 offset:7168
  ds_read_b64_tr_b16 v[140:141], v237 offset:6528
  ds_read_b64_tr_b16 v[142:143], v238 offset:6528
  ds_read_b64_tr_b16 v[144:145], v239 offset:6528
  ds_read_b64_tr_b16 v[146:147], v240 offset:6528
  v_exp_f32 v172, v172
  v_exp_f32 v173, v173
  v_exp_f32 v174, v174
  v_exp_f32 v175, v175
  v_exp_f32 v176, v176
  v_exp_f32 v177, v177
  v_exp_f32 v178, v178
  v_exp_f32 v179, v179
  v_cvt_pk_bf16_f32 v172, v172, v173
  v_cvt_pk_bf16_f32 v173, v174, v175
  v_cvt_pk_bf16_f32 v174, v176, v177
  v_cvt_pk_bf16_f32 v175, v178, v179
  v_exp_f32 v180, v180
  v_exp_f32 v181, v181
  v_exp_f32 v182, v182
  v_exp_f32 v183, v183
  s_waitcnt lgkmcnt(7)
  v_mfma_f32_32x32x16_bf16 v[188:203], v[148:151], v[172:175], v[188:203]
  v_exp_f32 v184, v184
  v_exp_f32 v185, v185
  v_exp_f32 v186, v186
  v_exp_f32 v187, v187
  v_cvt_pk_bf16_f32 v176, v180, v181
  v_cvt_pk_bf16_f32 v177, v182, v183
  v_cvt_pk_bf16_f32 v178, v184, v185
  v_cvt_pk_bf16_f32 v179, v186, v187
  s_waitcnt lgkmcnt(5)
  s_nop 0
  v_mfma_f32_32x32x16_bf16 v[188:203], v[152:155], v[176:179], v[188:203]
  s_waitcnt lgkmcnt(4)
  v_mfma_f32_32x32x16_bf16 v[172:187], v[136:139], v[128:131], 0
  ds_read_b128 v[132:135], v236 offset:8192
  ds_read_b64_tr_b16 v[148:149], v237 offset:7616
  ds_read_b64_tr_b16 v[150:151], v238 offset:7616
  ds_read_b64_tr_b16 v[152:153], v239 offset:7616
  ds_read_b64_tr_b16 v[154:155], v240 offset:7616
  v_exp_f32 v156, v156
  v_exp_f32 v157, v157
  v_exp_f32 v158, v158
  v_exp_f32 v159, v159
  v_exp_f32 v160, v160
  v_exp_f32 v161, v161
  v_exp_f32 v162, v162
  v_exp_f32 v163, v163
  v_cvt_pk_bf16_f32 v156, v156, v157
  v_cvt_pk_bf16_f32 v157, v158, v159
  v_cvt_pk_bf16_f32 v158, v160, v161
  v_cvt_pk_bf16_f32 v159, v162, v163
  v_exp_f32 v164, v164
  v_exp_f32 v165, v165
  v_exp_f32 v166, v166
  v_exp_f32 v167, v167
  s_waitcnt lgkmcnt(7)
  v_mfma_f32_32x32x16_bf16 v[188:203], v[140:143], v[156:159], v[188:203]
  v_exp_f32 v168, v168
  v_exp_f32 v169, v169
  v_exp_f32 v170, v170
  v_exp_f32 v171, v171
  v_cvt_pk_bf16_f32 v160, v164, v165
  v_cvt_pk_bf16_f32 v161, v166, v167
  v_cvt_pk_bf16_f32 v162, v168, v169
  v_cvt_pk_bf16_f32 v163, v170, v171
  s_waitcnt lgkmcnt(5)
  s_nop 0
  v_mfma_f32_32x32x16_bf16 v[188:203], v[144:147], v[160:163], v[188:203]
  s_waitcnt lgkmcnt(0)
  s_cmp_ge_u32 s42, 4
  s_cbranch_scc1 L_hskip_27
  s_cmp_lg_u32 s42, 0
  s_cbranch_scc1 L_ow_28
  s_waitcnt vmcnt(0)
  s_mov_b32 s59, 200000
  s_nop 4
L_spin_29:
  s_mov_b64 exec, -1
  v_cmp_ne_u32 vcc, 1, v253
  s_mov_b64 exec, -1
  s_nop 3
  s_cbranch_vccz L_ok_30
  s_sub_u32 s59, s59, 1
  s_cmp_eq_u32 s59, 0
  s_cbranch_scc1 L_ok_30
  s_mov_b64 exec, -1
    buffer_load_dword v253, v254, s[20:23], s65 offen sc1
  s_mov_b64 exec, -1
    s_waitcnt vmcnt(0)
  s_sleep 1
  s_branch L_spin_29
L_ok_30:
  v_mov_b32 v254, 156736
  v_mov_b32 v253, 1
    ds_write_b32 v254, v253
L_ow_28:
  v_mov_b32 v254, 156736
  s_mov_b32 s59, 12800000
  s_nop 4
L_sig_31:
    ds_read_b32 v253, v254
    s_waitcnt lgkmcnt(0)
    v_readfirstlane_b32 s58, v253
    s_nop 3
  s_cmp_lg_u32 s58, 0
  s_cbranch_scc1 L_sigok_32
  s_sub_u32 s59, s59, 1
  s_cmp_eq_u32 s59, 0
  s_cbranch_scc1 L_sigok_32
  s_branch L_sig_31
L_sigok_32:
  s_add_u32 m0, s64, 0
  s_cmp_ge_u32 s70, 14
  s_cselect_b32 s72, 57344, 0
  s_sub_u32 s72, s62, s72
  s_add_u32 s72, s72, 0
  buffer_load_dwordx4 v252, s[20:23], s72 offen sc1 lds
  buffer_load_dwordx4 v252, s[20:23], s72 offen offset:1024 sc1 lds
  s_add_u32 m0, s64, 8192
  s_add_u32 s72, s72, 57344
  buffer_load_dwordx4 v252, s[20:23], s72 offen sc1 lds
  buffer_load_dwordx4 v252, s[20:23], s72 offen offset:1024 sc1 lds
  s_add_u32 m0, s64, 16384
  s_cmp_ge_u32 s70, 13
  s_cselect_b32 s72, 57344, 0
  s_sub_u32 s72, s62, s72
  s_add_u32 s72, s72, 4096
  buffer_load_dwordx4 v252, s[20:23], s72 offen sc1 lds
  buffer_load_dwordx4 v252, s[20:23], s72 offen offset:1024 sc1 lds
  s_add_u32 m0, s64, 24576
  s_add_u32 s72, s72, 57344
  buffer_load_dwordx4 v252, s[20:23], s72 offen sc1 lds
  buffer_load_dwordx4 v252, s[20:23], s72 offen offset:1024 sc1 lds
L_hskip_27:
  v_mfma_f32_32x32x16_bf16 v[156:171], v[132:135], v[128:131], v[220:235]
  ds_read_b64_tr_b16 v[140:141], v237 offset:8704
  ds_read_b64_tr_b16 v[142:143], v238 offset:8704
  ds_read_b64_tr_b16 v[144:145], v239 offset:8704
  ds_read_b64_tr_b16 v[146:147], v240 offset:8704
  v_exp_f32 v172, v172
  v_exp_f32 v173, v173
  v_exp_f32 v174, v174
  v_exp_f32 v175, v175
  v_exp_f32 v176, v176
  v_exp_f32 v177, v177
  v_exp_f32 v178, v178
  v_exp_f32 v179, v179
  v_cvt_pk_bf16_f32 v172, v172, v173
  v_cvt_pk_bf16_f32 v173, v174, v175
  v_cvt_pk_bf16_f32 v174, v176, v177
  v_cvt_pk_bf16_f32 v175, v178, v179
  v_exp_f32 v180, v180
  v_exp_f32 v181, v181
  v_exp_f32 v182, v182
  v_exp_f32 v183, v183
  v_mfma_f32_32x32x16_bf16 v[188:203], v[148:151], v[172:175], v[188:203]
  v_exp_f32 v184, v184
  v_exp_f32 v185, v185
  v_exp_f32 v186, v186
  v_exp_f32 v187, v187
  v_cvt_pk_bf16_f32 v176, v180, v181
  v_cvt_pk_bf16_f32 v177, v182, v183
  v_cvt_pk_bf16_f32 v178, v184, v185
  v_cvt_pk_bf16_f32 v179, v186, v187
  s_nop 1
  v_mfma_f32_32x32x16_bf16 v[188:203], v[152:155], v[176:179], v[188:203]
  s_cmp_ge_u32 s42, 4
  s_cbranch_scc1 L_hskip_33
  s_add_u32 m0, s64, 98304
  s_cmp_ge_u32 s70, 12
  s_cselect_b32 s72, 57344, 0
  s_sub_u32 s72, s62, s72
  s_add_u32 s72, s72, 8192
  buffer_load_dwordx4 v252, s[20:23], s72 offen sc1 lds
  buffer_load_dwordx4 v252, s[20:23], s72 offen offset:1024 sc1 lds
  s_add_u32 m0, s64, 106496
  s_add_u32 s72, s72, 57344
  buffer_load_dwordx4 v252, s[20:23], s72 offen sc1 lds
  buffer_load_dwordx4 v252, s[20:23], s72 offen offset:1024 sc1 lds
L_hskip_33:
  v_exp_f32 v156, v156
  v_exp_f32 v157, v157
  v_exp_f32 v158, v158
  v_exp_f32 v159, v159
  v_exp_f32 v160, v160
  v_exp_f32 v161, v161
  v_exp_f32 v162, v162
  v_exp_f32 v163, v163
  v_cvt_pk_bf16_f32 v156, v156, v157
  v_cvt_pk_bf16_f32 v157, v158, v159
  v_cvt_pk_bf16_f32 v158, v160, v161
  v_cvt_pk_bf16_f32 v159, v162, v163
  v_exp_f32 v164, v164
  v_exp_f32 v165, v165
  v_exp_f32 v166, v166
  v_exp_f32 v167, v167
  s_waitcnt lgkmcnt(2)
  v_mfma_f32_32x32x16_bf16 v[188:203], v[140:143], v[156:159], v[188:203]
  v_exp_f32 v168, v168
  v_exp_f32 v169, v169
  v_exp_f32 v170, v170
  v_exp_f32 v171, v171
  v_cvt_pk_bf16_f32 v160, v164, v165
  v_cvt_pk_bf16_f32 v161, v166, v167
  v_cvt_pk_bf16_f32 v162, v168, v169
  v_cvt_pk_bf16_f32 v163, v170, v171
  s_waitcnt lgkmcnt(0)
  s_nop 0
  v_mfma_f32_32x32x16_bf16 v[188:203], v[144:147], v[160:163], v[188:203]
  v_mov_b32 v242, 0x30800000
  v_mov_b32 v243, 0x4e800000
  s_nop 9
  v_cmp_gt_f32 vcc, v196, v242
  v_cmp_lt_f32 s[52:53], v196, v243
  s_nop 0
  s_and_b64 vcc, vcc, s[52:53]
  s_cmp_eq_u64 vcc, -1
  s_nop 1
  s_cbranch_scc1 L_attok_34
    s_sub_u32 s53, 8, s42
    s_cmp_eq_u32 s93, 0
    s_cselect_b32 s53, s53, 0
    s_mov_b32 s52, s53
    s_lshl_b32 s54, s52, 10
    v_add_u32 v242, s54, v236
    v_mov_b32 v243, 0xf149f2ca
  L_fb1_35:
    ds_read_b128 v[132:135], v242
    s_waitcnt lgkmcnt(0)
    s_cmp_eq_u32 s52, 0
    s_cbranch_scc1 L_fq1a_37
    s_cmp_eq_u32 s52, 8
    s_cbranch_scc1 L_fq1b_38
    v_mfma_f32_32x32x16_bf16 v[156:171], v[132:135], v[128:131], 0
    s_branch L_fq1c_39
  L_fq1a_37:
    v_mfma_f32_32x32x16_bf16 v[156:171], v[132:135], v[128:131], v[204:219]
    s_branch L_fq1c_39
  L_fq1b_38:
    v_mfma_f32_32x32x16_bf16 v[156:171], v[132:135], v[128:131], v[220:235]
  L_fq1c_39:
    s_nop 15
    v_max3_f32 v243, v156, v157, v243
    v_max3_f32 v243, v158, v159, v243
    v_max3_f32 v243, v160, v161, v243
    v_max3_f32 v243, v162, v163, v243
    v_max3_f32 v243, v164, v165, v243
    v_max3_f32 v243, v166, v167, v243
    v_max3_f32 v243, v168, v169, v243
    v_max3_f32 v243, v170, v171, v243
    v_add_u32 v242, 1024, v242
    s_add_u32 s52, s52, 1
    s_cmp_lt_u32 s52, 9
    s_cbranch_scc1 L_fb1_35
    v_mov_b32 v244, v243
    s_nop 1
    v_permlane32_swap_b32 v243, v244
    s_nop 1
    v_max_f32 v243, v243, v244
    v_mov_b32 v188, 0
    v_mov_b32 v189, 0
    v_mov_b32 v190, 0
    v_mov_b32 v191, 0
    v_mov_b32 v192, 0
    v_mov_b32 v193, 0
    v_mov_b32 v194, 0
    v_mov_b32 v195, 0
    v_mov_b32 v196, 0
    v_mov_b32 v197, 0
    v_mov_b32 v198, 0
    v_mov_b32 v199, 0
    v_mov_b32 v200, 0
    v_mov_b32 v201, 0
    v_mov_b32 v202, 0
    v_mov_b32 v203, 0
    s_mov_b32 s52, s53
    s_lshl_b32 s54, s52, 10
    v_add_u32 v242, s54, v236
    s_mul_i32 s54, s52, 1088
    v_add_u32 v245, s54, v237
    v_add_u32 v246, s54, v238
    v_add_u32 v247, s54, v239
    v_add_u32 v248, s54, v240
  L_fb2_36:
    ds_read_b128 v[132:135], v242
    s_waitcnt lgkmcnt(0)
    s_cmp_eq_u32 s52, 0
    s_cbranch_scc1 L_fq2a_40
    s_cmp_eq_u32 s52, 8
    s_cbranch_scc1 L_fq2b_41
    v_mfma_f32_32x32x16_bf16 v[156:171], v[132:135], v[128:131], 0
    s_branch L_fq2c_42
  L_fq2a_40:
    v_mfma_f32_32x32x16_bf16 v[156:171], v[132:135], v[128:131], v[204:219]
    s_branch L_fq2c_42
  L_fq2b_41:
    v_mfma_f32_32x32x16_bf16 v[156:171], v[132:135], v[128:131], v[220:235]
  L_fq2c_42:
    s_nop 15
    ds_read_b64_tr_b16 v[140:141], v245
    ds_read_b64_tr_b16 v[142:143], v246
    ds_read_b64_tr_b16 v[144:145], v247
    ds_read_b64_tr_b16 v[146:147], v248
    v_sub_f32 v156, v156, v243
    v_sub_f32 v157, v157, v243
    v_sub_f32 v158, v158, v243
    v_sub_f32 v159, v159, v243
    v_sub_f32 v160, v160, v243
    v_sub_f32 v161, v161, v243
    v_sub_f32 v162, v162, v243
    v_sub_f32 v163, v163, v243
    v_sub_f32 v164, v164, v243
    v_sub_f32 v165, v165, v243
    v_sub_f32 v166, v166, v243
    v_sub_f32 v167, v167, v243
    v_sub_f32 v168, v168, v243
    v_sub_f32 v169, v169, v243
    v_sub_f32 v170, v170, v243
    v_sub_f32 v171, v171, v243
    v_exp_f32 v156, v156
    v_exp_f32 v157, v157
    v_exp_f32 v158, v158
    v_exp_f32 v159, v159
    v_exp_f32 v160, v160
    v_exp_f32 v161, v161
    v_exp_f32 v162, v162
    v_exp_f32 v163, v163
    v_exp_f32 v164, v164
    v_exp_f32 v165, v165
    v_exp_f32 v166, v166
    v_exp_f32 v167, v167
    v_exp_f32 v168, v168
    v_exp_f32 v169, v169
    v_exp_f32 v170, v170
    v_exp_f32 v171, v171
    s_nop 1
    v_cvt_pk_bf16_f32 v156, v156, v157
    v_cvt_pk_bf16_f32 v157, v158, v159
    v_cvt_pk_bf16_f32 v158, v160, v161
    v_cvt_pk_bf16_f32 v159, v162, v163
    v_cvt_pk_bf16_f32 v160, v164, v165
    v_cvt_pk_bf16_f32 v161, v166, v167
    v_cvt_pk_bf16_f32 v162, v168, v169
    v_cvt_pk_bf16_f32 v163, v170, v171
    s_waitcnt lgkmcnt(0)
    s_nop 1
    v_mfma_f32_32x32x16_bf16 v[188:203], v[140:143], v[156:159], v[188:203]
    v_mfma_f32_32x32x16_bf16 v[188:203], v[144:147], v[160:163], v[188:203]
    v_add_u32 v242, 1024, v242
    v_add_u32 v245, 1088, v245
    v_add_u32 v246, 1088, v246
    v_add_u32 v247, 1088, v247
    v_add_u32 v248, 1088, v248
    s_add_u32 s52, s52, 1
    s_cmp_lt_u32 s52, 9
    s_cbranch_scc1 L_fb2_36
    s_nop 15
L_attok_34:
  v_rcp_f32 v242, v196
  s_lshl_b32 s99, s93, 3
  s_add_u32 s99, s99, s42
  s_lshl_b32 s99, s99, 5
  s_add_u32 s99, s99, s92
  s_lshl_b32 s56, s99, 2
  s_add_u32 s56, s56, 15749120
  s_lshl_b32 s99, s99, 10
  s_add_u32 s99, s99, 13631488
  v_mul_f32 v188, v188, v242
  v_mul_f32 v189, v189, v242
  v_mul_f32 v190, v190, v242
  v_mul_f32 v191, v191, v242
  v_mul_f32 v192, v192, v242
  v_mul_f32 v193, v193, v242
  v_mul_f32 v194, v194, v242
  v_mul_f32 v195, v195, v242
  v_cvt_pk_bf16_f32 v188, v188, v189
  v_cvt_pk_bf16_f32 v189, v190, v191
  v_cvt_pk_bf16_f32 v190, v192, v193
  v_cvt_pk_bf16_f32 v191, v194, v195
  buffer_store_dwordx4 v[188:191], v252, s[20:23], s99 offen sc1
  s_and_b32 s99, s42, 1
  s_lshl_b32 s99, s99, 12
  s_lshr_b32 s100, s42, 2
  s_lshl_b32 s100, s100, 13
  s_add_u32 s99, s99, s100
  v_add_u32 v120, s99, v252
  v_add_u32 v121, 98304, v120
  v_and_b32 v242, 15, v1
  v_lshrrev_b32 v242, 2, v242
  v_and_b32 v243, 3, v1
  v_lshrrev_b32 v244, 4, v1
  v_and_b32 v244, 1, v244
  v_lshlrev_b32 v244, 1, v244
  v_lshrrev_b32 v245, 1, v243
  v_add_u32 v244, v244, v245
  s_lshr_b32 s99, s42, 1
  s_and_b32 s99, s99, 1
  s_lshl_b32 s52, s99, 2
  v_add_u32 v244, s52, v244
  v_lshrrev_b32 v245, 1, v242
  v_lshlrev_b32 v245, 2, v245
  v_xor_b32 v244, v244, v245
  v_lshlrev_b32 v244, 4, v244
  v_and_b32 v245, 1, v243
  v_lshl_add_u32 v244, v245, 3, v244
  v_lshrrev_b32 v246, 5, v1
  v_lshl_add_u32 v245, v246, 2, v242
  v_lshl_add_u32 v244, v245, 7, v244
  s_add_u32 s3, s100, 32768
  v_add_u32 v122, s3, v244
  v_add_u32 v123, 114688, v122
  v_add_u32 v124, s64, v252
  v_add_u32 v124, 98304, v124
  s_xor_b32 s100, s64, 8192
  v_add_u32 v125, s100, v252
  v_add_u32 v125, 98304, v125
  s_lshl_b32 s100, s95, 6
  s_lshl_b32 s99, s99, 5
  s_add_u32 s100, s100, s99
  s_lshr_b32 s99, s42, 2
  s_lshl_b32 s99, s99, 4
  s_add_u32 s100, s100, s99
  v_lshlrev_b32 v245, 2, v246
  v_add_u32 v245, s100, v245
  v_lshlrev_b32 v127, 1, v245
  v_lshrrev_b32 v242, 3, v1
  s_lshl_b32 s99, s42, 3
  v_add_u32 v242, s99, v242
  v_lshlrev_b32 v242, 10, v242
  v_and_b32 v243, 7, v1
  v_lshl_add_u32 v126, v243, 4, v242
  s_lshl_b32 s3, s94, 16
  s_lshl_b32 s99, s95, 7
  s_add_u32 s3, s3, s99
  v_and_b32 v5, 31, v1
  v_lshlrev_b32 v5, 3, v5
  s_and_b32 s99, s42, 1
  s_lshl1_add_u32 s99, s94, s99
  s_lshl_b32 s99, s99, 8
  s_add_u32 s73, s99, 15761408
  s_waitcnt vmcnt(5)
  s_barrier
  ds_read_b128 v[132:135], v120 offset:0
  ds_read_b128 v[140:143], v120 offset:1024
  s_waitcnt lgkmcnt(1)
  v_mfma_f32_32x32x16_bf16 v[164:179], v[8:11], v[132:135], 0
  ds_read_b128 v[148:151], v120 offset:2048
  s_add_u32 m0, s64, 114688
  s_cmp_ge_u32 s70, 11
  s_cselect_b32 s72, 57344, 0
  s_sub_u32 s72, s62, s72
  s_add_u32 s72, s72, 12288
  buffer_load_dwordx4 v252, s[20:23], s72 offen sc1 lds
  s_waitcnt lgkmcnt(1)
  v_mfma_f32_32x32x16_bf16 v[164:179], v[12:15], v[140:143], v[164:179]
  ds_read_b128 v[156:159], v120 offset:3072
  buffer_load_dwordx4 v252, s[20:23], s72 offen offset:1024 sc1 lds
  s_waitcnt vmcnt(3)
  s_barrier
  s_waitcnt lgkmcnt(1)
  v_mfma_f32_32x32x16_bf16 v[164:179], v[16:19], v[148:151], v[164:179]
  ds_read_b128 v[132:135], v120 offset:16384
  s_add_u32 m0, s64, 147456
  s_add_u32 s57, s61, 0
  buffer_load_dwordx4 v6, s[28:31], s57 offen lds
  s_waitcnt lgkmcnt(1)
  v_mfma_f32_32x32x16_bf16 v[164:179], v[20:23], v[156:159], v[164:179]
  ds_read_b128 v[140:143], v120 offset:17408
  s_add_u32 m0, s64, 148480
  s_add_u32 s57, s61, 8192
  buffer_load_dwordx4 v6, s[28:31], s57 offen lds
  s_waitcnt lgkmcnt(1)
  v_mfma_f32_32x32x16_bf16 v[164:179], v[24:27], v[132:135], v[164:179]
  s_add_u32 m0, s64, 131072
  s_cmp_ge_u32 s70, 10
  s_cselect_b32 s72, 57344, 0
  s_sub_u32 s72, s62, s72
  s_add_u32 s72, s72, 16384
  buffer_load_dwordx4 v252, s[20:23], s72 offen sc1 lds
  ds_read_b128 v[148:151], v120 offset:18432
  s_waitcnt lgkmcnt(1)
  v_mfma_f32_32x32x16_bf16 v[164:179], v[28:31], v[140:143], v[164:179]
  buffer_load_dwordx4 v252, s[20:23], s72 offen offset:1024 sc1 lds
  ds_read_b128 v[156:159], v120 offset:19456
  s_barrier
  s_waitcnt lgkmcnt(1)
  v_mfma_f32_32x32x16_bf16 v[164:179], v[32:35], v[148:151], v[164:179]
  ds_read_b128 v[132:135], v121 offset:0
  s_add_u32 m0, s64, 0
  s_cmp_ge_u32 s70, 9
  s_cselect_b32 s72, 57344, 0
  s_sub_u32 s72, s62, s72
  s_add_u32 s72, s72, 20480
  buffer_load_dwordx4 v252, s[20:23], s72 offen sc1 lds
  s_waitcnt lgkmcnt(1)
  v_mfma_f32_32x32x16_bf16 v[164:179], v[36:39], v[156:159], v[164:179]
  ds_read_b128 v[140:143], v121 offset:1024
  buffer_load_dwordx4 v252, s[20:23], s72 offen offset:1024 sc1 lds
  s_waitcnt lgkmcnt(1)
  v_mfma_f32_32x32x16_bf16 v[164:179], v[40:43], v[132:135], v[164:179]
  ds_read_b128 v[148:151], v121 offset:2048
  buffer_load_dwordx2 v[238:239], v5, s[20:23], s73 offen sc1
  s_waitcnt lgkmcnt(1)
  v_mfma_f32_32x32x16_bf16 v[164:179], v[44:47], v[140:143], v[164:179]
  ds_read_b128 v[156:159], v121 offset:3072
  s_waitcnt vmcnt(5)
  s_barrier
  s_waitcnt lgkmcnt(1)
  v_mfma_f32_32x32x16_bf16 v[164:179], v[48:51], v[148:151], v[164:179]
  ds_read_b128 v[132:135], v121 offset:16384
  ds_read_b64_tr_b16 v[8:9], v123 offset:0
  ds_read_b64_tr_b16 v[10:11], v123 offset:1024
  s_add_u32 m0, s64, 16384
  s_cmp_ge_u32 s70, 8
  s_cselect_b32 s72, 57344, 0
  s_sub_u32 s72, s62, s72
  s_add_u32 s72, s72, 24576
  buffer_load_dwordx4 v252, s[20:23], s72 offen sc1 lds
  s_waitcnt lgkmcnt(3)
  v_mfma_f32_32x32x16_bf16 v[164:179], v[52:55], v[156:159], v[164:179]
  ds_read_b128 v[140:143], v121 offset:17408
  ds_read_b64_tr_b16 v[12:13], v123 offset:2048
  ds_read_b64_tr_b16 v[14:15], v123 offset:3072
  buffer_load_dwordx4 v252, s[20:23], s72 offen offset:1024 sc1 lds
  s_waitcnt lgkmcnt(5)
  v_mfma_f32_32x32x16_bf16 v[164:179], v[56:59], v[132:135], v[164:179]
  ds_read_b64_tr_b16 v[16:17], v123 offset:4096
  ds_read_b64_tr_b16 v[18:19], v123 offset:5120
  ds_read_b128 v[148:151], v121 offset:18432
  s_waitcnt lgkmcnt(5)
  v_mfma_f32_32x32x16_bf16 v[164:179], v[60:63], v[140:143], v[164:179]
  ds_read_b64_tr_b16 v[20:21], v123 offset:6144
  ds_read_b64_tr_b16 v[22:23], v123 offset:7168
  ds_read_b128 v[156:159], v121 offset:19456
  v_mov_b32 v216, 0
  v_mov_b32 v217, 1
  s_mov_b64 exec, 0x1
  buffer_store_dword v217, v216, s[20:23], s56 offen sc1
  s_mov_b64 exec, -1
  s_waitcnt lgkmcnt(0)
  s_waitcnt vmcnt(6)
  s_barrier
  v_mfma_f32_32x32x16_bf16 v[164:179], v[64:67], v[148:151], v[164:179]
  ds_read_b128 v[132:135], v121 offset:32768
  s_add_u32 m0, s64, 98304
  s_cmp_ge_u32 s70, 7
  s_cselect_b32 s72, 57344, 0
  s_sub_u32 s72, s62, s72
  s_add_u32 s72, s72, 28672
  buffer_load_dwordx4 v252, s[20:23], s72 offen sc1 lds
  v_mfma_f32_32x32x16_bf16 v[164:179], v[68:71], v[156:159], v[164:179]
  ds_read_b128 v[140:143], v121 offset:33792
  buffer_load_dwordx4 v252, s[20:23], s72 offen offset:1024 sc1 lds
  s_waitcnt lgkmcnt(1)
  v_mfma_f32_32x32x16_bf16 v[164:179], v[72:75], v[132:135], v[164:179]
  s_add_u32 m0, s64, 147456
  s_add_u32 s57, s61, 65536
  buffer_load_dwordx4 v6, s[28:31], s57 offen lds
  ds_read_b128 v[148:151], v121 offset:34816
  global_load_dwordx2 v[208:209], v127, s[38:39]
  s_waitcnt lgkmcnt(1)
  v_mfma_f32_32x32x16_bf16 v[164:179], v[76:79], v[140:143], v[164:179]
  s_add_u32 m0, s64, 148480
  s_add_u32 s57, s61, 73728
  buffer_load_dwordx4 v6, s[28:31], s57 offen lds
  ds_read_b128 v[156:159], v121 offset:35840
  global_load_dwordx2 v[210:211], v127, s[38:39] offset:16
  s_waitcnt vmcnt(10)
  s_barrier
  s_waitcnt lgkmcnt(1)
  v_mfma_f32_32x32x16_bf16 v[164:179], v[80:83], v[148:151], v[164:179]
  ds_read_b128 v[132:135], v120 offset:0
  s_add_u32 m0, s64, 114688
  s_cmp_ge_u32 s70, 6
  s_cselect_b32 s72, 57344, 0
  s_sub_u32 s72, s62, s72
  s_add_u32 s72, s72, 32768
  buffer_load_dwordx4 v252, s[20:23], s72 offen sc1 lds
  s_waitcnt lgkmcnt(1)
  v_mfma_f32_32x32x16_bf16 v[164:179], v[84:87], v[156:159], v[164:179]
  ds_read_b128 v[140:143], v120 offset:1024
  buffer_load_dwordx4 v252, s[20:23], s72 offen offset:1024 sc1 lds
  buffer_load_dwordx4 v[212:215], v126, s[4:7], s3 offen
  s_waitcnt lgkmcnt(1)
  v_mfma_f32_32x32x16_bf16 v[164:179], v[88:91], v[132:135], v[164:179]
  ds_read_b128 v[148:151], v120 offset:2048
  s_waitcnt vmcnt(12)
  v_cmp_eq_u32 vcc, 0xbf800000, v239
  s_nop 0
  s_cbranch_vccnz L_rspin_43
L_rok_44:
  v_add_f32 v242, 0x3727c5ac, v239
  v_rsq_f32 v242, v242
  s_nop 0
  v_mul_f32 v240, v239, v242
  v_mul_f32 v240, v240, v242
  v_add_f32 v240, 0x3727c5ac, v240
  v_rsq_f32 v240, v240
  s_nop 0
  v_mul_f32 v240, v240, v242
  s_waitcnt lgkmcnt(1)
  v_mfma_f32_32x32x16_bf16 v[164:179], v[92:95], v[140:143], v[164:179]
  ds_read_b128 v[156:159], v120 offset:3072
  s_waitcnt vmcnt(4)
  s_barrier
  s_waitcnt lgkmcnt(1)
  v_mfma_f32_32x32x16_bf16 v[164:179], v[96:99], v[148:151], v[164:179]
  ds_read_b128 v[132:135], v120 offset:16384
  ds_read_b64_tr_b16 v[24:25], v123 offset:0
  ds_read_b64_tr_b16 v[26:27], v123 offset:1024
  s_add_u32 m0, s64, 131072
  s_cmp_ge_u32 s70, 5
  s_cselect_b32 s72, 57344, 0
  s_sub_u32 s72, s62, s72
  s_add_u32 s72, s72, 36864
  buffer_load_dwordx4 v252, s[20:23], s72 offen sc1 lds
  s_waitcnt lgkmcnt(3)
  v_mfma_f32_32x32x16_bf16 v[164:179], v[100:103], v[156:159], v[164:179]
  ds_read_b128 v[140:143], v120 offset:17408
  ds_read_b64_tr_b16 v[28:29], v123 offset:2048
  ds_read_b64_tr_b16 v[30:31], v123 offset:3072
  buffer_load_dwordx4 v252, s[20:23], s72 offen offset:1024 sc1 lds
  s_waitcnt lgkmcnt(5)
  v_mfma_f32_32x32x16_bf16 v[164:179], v[104:107], v[132:135], v[164:179]
  ds_read_b64_tr_b16 v[32:33], v123 offset:4096
  ds_read_b64_tr_b16 v[34:35], v123 offset:5120
  ds_read_b128 v[148:151], v120 offset:18432
  s_waitcnt lgkmcnt(5)
  v_mfma_f32_32x32x16_bf16 v[164:179], v[108:111], v[140:143], v[164:179]
  ds_read_b64_tr_b16 v[36:37], v123 offset:6144
  ds_read_b64_tr_b16 v[38:39], v123 offset:7168
  ds_read_b128 v[156:159], v120 offset:19456
  s_waitcnt lgkmcnt(0)
  s_barrier
  v_mfma_f32_32x32x16_bf16 v[164:179], v[112:115], v[148:151], v[164:179]
  ds_read_b128 v[132:135], v121 offset:0
  ds_read_b64_tr_b16 v[136:137], v122 offset:49152
  ds_read_b64_tr_b16 v[138:139], v122 offset:50176
  s_add_u32 m0, s64, 0
  s_cmp_ge_u32 s70, 4
  s_cselect_b32 s72, 57344, 0
  s_sub_u32 s72, s62, s72
  s_add_u32 s72, s72, 40960
  buffer_load_dwordx4 v252, s[20:23], s72 offen sc1 lds
  v_mfma_f32_32x32x16_bf16 v[164:179], v[116:119], v[156:159], v[164:179]
  ds_read_b128 v[140:143], v121 offset:1024
  ds_read_b64_tr_b16 v[144:145], v122 offset:51200
  ds_read_b64_tr_b16 v[146:147], v122 offset:52224
  buffer_load_dwordx4 v252, s[20:23], s72 offen offset:1024 sc1 lds
  s_waitcnt lgkmcnt(3)
  v_mfma_f32_32x32x16_bf16 v[164:179], v[136:139], v[132:135], v[164:179]
  s_add_u32 m0, s64, 147456
  s_add_u32 s57, s61, 131072
  buffer_load_dwordx4 v6, s[28:31], s57 offen lds
  ds_read_b128 v[148:151], v121 offset:2048
  ds_read_b64_tr_b16 v[152:153], v122 offset:53248
  ds_read_b64_tr_b16 v[154:155], v122 offset:54272
  s_waitcnt lgkmcnt(3)
  v_mfma_f32_32x32x16_bf16 v[164:179], v[144:147], v[140:143], v[164:179]
  s_add_u32 m0, s64, 148480
  s_add_u32 s57, s61, 139264
  buffer_load_dwordx4 v6, s[28:31], s57 offen lds
  ds_read_b128 v[156:159], v121 offset:3072
  ds_read_b64_tr_b16 v[160:161], v122 offset:55296
  ds_read_b64_tr_b16 v[162:163], v122 offset:56320
  s_waitcnt vmcnt(7)
  s_barrier
  s_waitcnt lgkmcnt(3)
  v_mfma_f32_32x32x16_bf16 v[164:179], v[152:155], v[148:151], v[164:179]
  ds_read_b128 v[132:135], v121 offset:16384
  ds_read_b64_tr_b16 v[136:137], v122 offset:0
  ds_read_b64_tr_b16 v[138:139], v122 offset:1024
  s_add_u32 m0, s64, 16384
  s_cmp_ge_u32 s70, 3
  s_cselect_b32 s72, 57344, 0
  s_sub_u32 s72, s62, s72
  s_add_u32 s72, s72, 45056
  buffer_load_dwordx4 v252, s[20:23], s72 offen sc1 lds
  s_waitcnt lgkmcnt(3)
  v_mfma_f32_32x32x16_bf16 v[164:179], v[160:163], v[156:159], v[164:179]
  ds_read_b128 v[140:143], v121 offset:17408
  ds_read_b64_tr_b16 v[144:145], v122 offset:2048
  ds_read_b64_tr_b16 v[146:147], v122 offset:3072
  buffer_load_dwordx4 v252, s[20:23], s72 offen offset:1024 sc1 lds
  s_waitcnt lgkmcnt(3)
  v_mfma_f32_32x32x16_bf16 v[164:179], v[136:139], v[132:135], v[164:179]
  ds_read_b128 v[148:151], v121 offset:18432
  ds_read_b64_tr_b16 v[152:153], v122 offset:4096
  ds_read_b64_tr_b16 v[154:155], v122 offset:5120
  s_waitcnt lgkmcnt(3)
  v_mfma_f32_32x32x16_bf16 v[164:179], v[144:147], v[140:143], v[164:179]
  ds_read_b128 v[156:159], v121 offset:19456
  ds_read_b64_tr_b16 v[160:161], v122 offset:6144
  ds_read_b64_tr_b16 v[162:163], v122 offset:7168
  s_waitcnt vmcnt(2)
  s_barrier
  s_waitcnt lgkmcnt(3)
  v_mfma_f32_32x32x16_bf16 v[164:179], v[152:155], v[148:151], v[164:179]
  ds_read_b128 v[132:135], v121 offset:32768
  ds_read_b64_tr_b16 v[136:137], v122 offset:16384
  ds_read_b64_tr_b16 v[138:139], v122 offset:17408
  ds_read_b64_tr_b16 v[40:41], v123 offset:0
  ds_read_b64_tr_b16 v[42:43], v123 offset:1024
  s_add_u32 m0, s64, 98304
  s_cmp_ge_u32 s70, 2
  s_cselect_b32 s72, 57344, 0
  s_sub_u32 s72, s62, s72
  s_add_u32 s72, s72, 49152
  buffer_load_dwordx4 v252, s[20:23], s72 offen sc1 lds
  s_waitcnt lgkmcnt(5)
  v_mfma_f32_32x32x16_bf16 v[164:179], v[160:163], v[156:159], v[164:179]
  ds_read_b128 v[140:143], v121 offset:33792
  ds_read_b64_tr_b16 v[144:145], v122 offset:18432
  ds_read_b64_tr_b16 v[146:147], v122 offset:19456
  ds_read_b64_tr_b16 v[44:45], v123 offset:2048
  ds_read_b64_tr_b16 v[46:47], v123 offset:3072
  buffer_load_dwordx4 v252, s[20:23], s72 offen offset:1024 sc1 lds
  v_lshlrev_b32 v216, 2, v1
  s_lshl_b32 s99, s94, 8
  s_add_u32 s65, s99, 15749120
  s_cmp_lg_u32 s42, 0
  s_cbranch_scc1 L_ow_45
  s_mov_b64 exec, -1
  buffer_load_dword v217, v216, s[20:23], s65 offen sc1
  s_mov_b64 exec, -1
L_ow_45:
  s_waitcnt lgkmcnt(7)
  v_mfma_f32_32x32x16_bf16 v[164:179], v[136:139], v[132:135], v[164:179]
  ds_read_b64_tr_b16 v[48:49], v123 offset:4096
  ds_read_b64_tr_b16 v[50:51], v123 offset:5120
  s_cmp_ge_u32 s70, 3
  s_cselect_b32 s71, 917504, 0
  s_sub_u32 s71, s60, s71
  s_add_u32 s71, s71, 720896
  s_add_u32 m0, s64, 81920
  s_mov_b32 s57, s71
  buffer_load_dwordx4 v6, s[24:27], s57 offen lds
  ds_read_b128 v[148:151], v121 offset:34816
  ds_read_b64_tr_b16 v[152:153], v122 offset:20480
  ds_read_b64_tr_b16 v[154:155], v122 offset:21504
  s_waitcnt lgkmcnt(7)
  v_mfma_f32_32x32x16_bf16 v[164:179], v[144:147], v[140:143], v[164:179]
  ds_read_b64_tr_b16 v[52:53], v123 offset:6144
  ds_read_b64_tr_b16 v[54:55], v123 offset:7168
  s_add_u32 m0, s64, 82944
  s_add_u32 s57, s71, 8192
  buffer_load_dwordx4 v6, s[24:27], s57 offen lds
  ds_read_b128 v[156:159], v121 offset:35840
  ds_read_b64_tr_b16 v[160:161], v122 offset:22528
  ds_read_b64_tr_b16 v[162:163], v122 offset:23552
  s_waitcnt lgkmcnt(0)
  s_barrier
  v_mfma_f32_32x32x16_bf16 v[164:179], v[152:155], v[148:151], v[164:179]
  ds_read_b128 v[132:135], v120 offset:0
  ds_read_b64_tr_b16 v[136:137], v122 offset:32768
  ds_read_b64_tr_b16 v[138:139], v122 offset:33792
  s_add_u32 m0, s64, 114688
  s_cmp_ge_u32 s70, 1
  s_cselect_b32 s72, 57344, 0
  s_sub_u32 s72, s62, s72
  s_add_u32 s72, s72, 53248
  buffer_load_dwordx4 v252, s[20:23], s72 offen sc1 lds
  v_mfma_f32_32x32x16_bf16 v[164:179], v[160:163], v[156:159], v[164:179]
  ds_read_b128 v[140:143], v120 offset:1024
  ds_read_b64_tr_b16 v[144:145], v122 offset:34816
  ds_read_b64_tr_b16 v[146:147], v122 offset:35840
  buffer_load_dwordx4 v252, s[20:23], s72 offen offset:1024 sc1 lds
  s_waitcnt lgkmcnt(3)
  v_mfma_f32_32x32x16_bf16 v[164:179], v[136:139], v[132:135], v[164:179]
  s_cmp_ge_u32 s70, 2
  s_cselect_b32 s71, 917504, 0
  s_sub_u32 s71, s60, s71
  s_add_u32 s71, s71, 786432
  s_add_u32 m0, s64, 32768
  s_mov_b32 s57, s71
  buffer_load_dwordx4 v6, s[24:27], s57 offen lds
  ds_read_b128 v[148:151], v120 offset:2048
  ds_read_b64_tr_b16 v[152:153], v122 offset:36864
  ds_read_b64_tr_b16 v[154:155], v122 offset:37888
  s_waitcnt lgkmcnt(3)
  v_mfma_f32_32x32x16_bf16 v[164:179], v[144:147], v[140:143], v[164:179]
  s_add_u32 m0, s64, 33792
  s_add_u32 s57, s71, 8192
  buffer_load_dwordx4 v6, s[24:27], s57 offen lds
  s_add_u32 m0, s64, 147456
  s_add_u32 s57, s61, 196608
  buffer_load_dwordx4 v6, s[28:31], s57 offen lds
  s_add_u32 m0, s64, 148480
  s_add_u32 s57, s61, 204800
  buffer_load_dwordx4 v6, s[28:31], s57 offen lds
  ds_read_b128 v[156:159], v120 offset:3072
  ds_read_b64_tr_b16 v[160:161], v122 offset:38912
  ds_read_b64_tr_b16 v[162:163], v122 offset:39936
  s_cmp_lg_u32 s42, 0
  s_cbranch_scc1 L_ow_46
  s_waitcnt vmcnt(8)
  s_mov_b32 s59, 200000
L_spin_47:
  s_mov_b64 exec, -1
  v_cmp_ne_u32 vcc, 1, v217
  s_mov_b64 exec, -1
  s_nop 3
  s_cbranch_vccz L_ok_48
  s_sub_u32 s59, s59, 1
  s_cmp_eq_u32 s59, 0
  s_cbranch_scc1 L_ok_48
  s_mov_b64 exec, -1
    buffer_load_dword v217, v216, s[20:23], s65 offen sc1
  s_mov_b64 exec, -1
    s_waitcnt vmcnt(0)
  s_sleep 1
  s_branch L_spin_47
L_ok_48:
L_ow_46:
  s_waitcnt vmcnt(10)
  s_waitcnt vmcnt(6)
  s_barrier
  s_waitcnt lgkmcnt(3)
  v_mfma_f32_32x32x16_bf16 v[164:179], v[152:155], v[148:151], v[164:179]
  ds_read_b128 v[132:135], v120 offset:16384
  ds_read_b64_tr_b16 v[136:137], v122 offset:49152
  ds_read_b64_tr_b16 v[138:139], v122 offset:50176
  s_add_u32 m0, s64, 131072
  s_add_u32 s72, s63, 0
  buffer_load_dwordx4 v252, s[20:23], s72 offen sc1 lds
  s_waitcnt lgkmcnt(3)
  v_mfma_f32_32x32x16_bf16 v[164:179], v[160:163], v[156:159], v[164:179]
  ds_read_b128 v[140:143], v120 offset:17408
  ds_read_b64_tr_b16 v[144:145], v122 offset:51200
  ds_read_b64_tr_b16 v[146:147], v122 offset:52224
  buffer_load_dwordx4 v252, s[20:23], s72 offen offset:1024 sc1 lds
  s_waitcnt lgkmcnt(3)
  v_mfma_f32_32x32x16_bf16 v[164:179], v[136:139], v[132:135], v[164:179]
  s_cmp_ge_u32 s70, 1
  s_cselect_b32 s71, 917504, 0
  s_sub_u32 s71, s60, s71
  s_add_u32 s71, s71, 851968
  s_add_u32 m0, s64, 49152
  s_mov_b32 s57, s71
  buffer_load_dwordx4 v6, s[24:27], s57 offen lds
  ds_read_b128 v[148:151], v120 offset:18432
  ds_read_b64_tr_b16 v[152:153], v122 offset:53248
  ds_read_b64_tr_b16 v[154:155], v122 offset:54272
  s_waitcnt lgkmcnt(3)
  v_mfma_f32_32x32x16_bf16 v[164:179], v[144:147], v[140:143], v[164:179]
  s_add_u32 m0, s64, 50176
  s_add_u32 s57, s71, 8192
  buffer_load_dwordx4 v6, s[24:27], s57 offen lds
  ds_read_b128 v[156:159], v120 offset:19456
  ds_read_b64_tr_b16 v[160:161], v122 offset:55296
  ds_read_b64_tr_b16 v[162:163], v122 offset:56320
  s_waitcnt vmcnt(4)
  s_barrier
  s_waitcnt lgkmcnt(3)
  v_mfma_f32_32x32x16_bf16 v[164:179], v[152:155], v[148:151], v[164:179]
  ds_read_b128 v[132:135], v121 offset:0
  ds_read_b64_tr_b16 v[136:137], v122 offset:0
  ds_read_b64_tr_b16 v[138:139], v122 offset:1024
  ds_read_b64_tr_b16 v[56:57], v123 offset:0
  ds_read_b64_tr_b16 v[58:59], v123 offset:1024
  s_add_u32 m0, s64, 0
  s_add_u32 s72, s63, 4096
  buffer_load_dwordx4 v252, s[20:23], s72 offen sc1 lds
  s_waitcnt lgkmcnt(5)
  v_mfma_f32_32x32x16_bf16 v[164:179], v[160:163], v[156:159], v[164:179]
  ds_read_b128 v[140:143], v121 offset:1024
  ds_read_b64_tr_b16 v[144:145], v122 offset:2048
  ds_read_b64_tr_b16 v[146:147], v122 offset:3072
  ds_read_b64_tr_b16 v[60:61], v123 offset:2048
  ds_read_b64_tr_b16 v[62:63], v123 offset:3072
  buffer_load_dwordx4 v252, s[20:23], s72 offen offset:1024 sc1 lds
  s_waitcnt lgkmcnt(7)
  v_mfma_f32_32x32x16_bf16 v[164:179], v[136:139], v[132:135], v[164:179]
  ds_read_b64_tr_b16 v[64:65], v123 offset:4096
  ds_read_b64_tr_b16 v[66:67], v123 offset:5120
  ds_read_b128 v[148:151], v121 offset:2048
  ds_read_b64_tr_b16 v[152:153], v122 offset:4096
  ds_read_b64_tr_b16 v[154:155], v122 offset:5120
  s_waitcnt lgkmcnt(7)
  v_mfma_f32_32x32x16_bf16 v[164:179], v[144:147], v[140:143], v[164:179]
  ds_read_b64_tr_b16 v[68:69], v123 offset:6144
  ds_read_b64_tr_b16 v[70:71], v123 offset:7168
  ds_read_b128 v[156:159], v121 offset:3072
  ds_read_b64_tr_b16 v[160:161], v122 offset:6144
  ds_read_b64_tr_b16 v[162:163], v122 offset:7168
  v_and_b32 v246, 31, v1
  s_and_b32 s99, s42, 1
  s_lshl_b32 s99, s99, 5
  v_add_u32 v246, s99, v246
  v_mul_u32_u24 v246, 144, v246
  s_lshr_b32 s99, s42, 1
  s_and_b32 s99, s99, 1
  s_lshl_b32 s99, s99, 6
  s_lshr_b32 s100, s42, 2
  s_lshl_b32 s100, s100, 5
  s_add_u32 s99, s99, s100
  s_add_u32 s99, s99, 131072
  v_lshrrev_b32 v247, 5, v1
  v_lshl_add_u32 v246, v247, 3, v246
  v_add_u32 v246, s99, v246
  v_mov_b32 v250, v246
  v_lshrrev_b32 v248, 3, v1
  s_lshl_b32 s99, s42, 3
  v_add_u32 v248, s99, v248
  v_mul_u32_u24 v248, 144, v248
  v_and_b32 v249, 7, v1
  v_lshl_add_u32 v248, v249, 4, v248
  v_add_u32 v248, 131072, v248
  v_mov_b32 v251, v248
  s_waitcnt lgkmcnt(0)
  s_waitcnt vmcnt(2)
  s_barrier
  v_mfma_f32_32x32x16_bf16 v[164:179], v[152:155], v[148:151], v[164:179]
  ds_read_b128 v[132:135], v121 offset:16384
  ds_read_b64_tr_b16 v[136:137], v122 offset:16384
  ds_read_b64_tr_b16 v[138:139], v122 offset:17408
  s_add_u32 m0, s64, 16384
  s_add_u32 s72, s63, 8192
  buffer_load_dwordx4 v252, s[20:23], s72 offen sc1 lds
  v_mfma_f32_32x32x16_bf16 v[164:179], v[160:163], v[156:159], v[164:179]
  ds_read_b128 v[140:143], v121 offset:17408
  ds_read_b64_tr_b16 v[144:145], v122 offset:18432
  ds_read_b64_tr_b16 v[146:147], v122 offset:19456
  buffer_load_dwordx4 v252, s[20:23], s72 offen offset:1024 sc1 lds
  s_waitcnt lgkmcnt(3)
  v_mfma_f32_32x32x16_bf16 v[164:179], v[136:139], v[132:135], v[164:179]
  ds_read_b128 v[148:151], v121 offset:18432
  ds_read_b64_tr_b16 v[152:153], v122 offset:20480
  ds_read_b64_tr_b16 v[154:155], v122 offset:21504
  s_waitcnt lgkmcnt(3)
  v_mfma_f32_32x32x16_bf16 v[164:179], v[144:147], v[140:143], v[164:179]
  ds_read_b128 v[156:159], v121 offset:19456
  ds_read_b64_tr_b16 v[160:161], v122 offset:22528
  ds_read_b64_tr_b16 v[162:163], v122 offset:23552
  s_barrier
  s_waitcnt lgkmcnt(3)
  v_mfma_f32_32x32x16_bf16 v[164:179], v[152:155], v[148:151], v[164:179]
  ds_read_b128 v[132:135], v121 offset:32768
  s_add_u32 m0, s64, 98304
  s_add_u32 s72, s63, 12288
  buffer_load_dwordx4 v252, s[20:23], s72 offen sc1 lds
  s_waitcnt lgkmcnt(1)
  v_mfma_f32_32x32x16_bf16 v[164:179], v[160:163], v[156:159], v[164:179]
  ds_read_b128 v[140:143], v121 offset:33792
  buffer_load_dwordx4 v252, s[20:23], s72 offen offset:1024 sc1 lds
  s_waitcnt lgkmcnt(1)
  v_mfma_f32_32x32x16_bf16 v[192:207], v[8:11], v[132:135], 0
  ds_read_b128 v[148:151], v121 offset:34816
  s_waitcnt lgkmcnt(0)
  s_cmp_ge_u32 s42, 4
  s_cbranch_scc1 L_xa_49
  s_nop 3
  ds_write_b128 v124, v[172:175] offset:49152
  ds_write_b128 v124, v[176:179] offset:50176
  s_waitcnt lgkmcnt(0)
  s_branch L_xb_50
L_xa_49:
  s_nop 3
  ds_write_b128 v124, v[164:167] offset:49152
  ds_write_b128 v124, v[168:171] offset:50176
  s_waitcnt lgkmcnt(0)
  v_mov_b32 v164, v172
  v_mov_b32 v165, v173
  v_mov_b32 v166, v174
  v_mov_b32 v167, v175
  v_mov_b32 v168, v176
  v_mov_b32 v169, v177
  v_mov_b32 v170, v178
  v_mov_b32 v171, v179
L_xb_50:
  v_mfma_f32_32x32x16_bf16 v[192:207], v[12:15], v[140:143], v[192:207]
  ds_read_b128 v[156:159], v121 offset:35840
  s_waitcnt vmcnt(4)
  s_barrier
  v_mfma_f32_32x32x16_bf16 v[192:207], v[16:19], v[148:151], v[192:207]
  ds_read_b128 v[132:135], v120 offset:0
  s_waitcnt lgkmcnt(1)
  v_mfma_f32_32x32x16_bf16 v[192:207], v[20:23], v[156:159], v[192:207]
  ds_read_b128 v[140:143], v120 offset:1024
  s_waitcnt lgkmcnt(1)
  v_mfma_f32_32x32x16_bf16 v[192:207], v[24:27], v[132:135], v[192:207]
  ds_read_b128 v[148:151], v120 offset:2048
  ds_read_b128 v[222:225], v125 offset:49152
  ds_read_b128 v[226:229], v125 offset:50176
  v_lshlrev_b32 v230, 16, v208
  v_and_b32 v231, s74, v208
  v_lshlrev_b32 v232, 16, v209
  v_and_b32 v233, s74, v209
  v_lshlrev_b32 v234, 16, v210
  s_waitcnt lgkmcnt(3)
  v_mfma_f32_32x32x16_bf16 v[192:207], v[28:31], v[140:143], v[192:207]
  ds_read_b128 v[156:159], v120 offset:3072
  v_and_b32 v235, s74, v210
  v_lshlrev_b32 v236, 16, v211
  v_and_b32 v237, s74, v211
  s_waitcnt lgkmcnt(2)
  v_add_f32 v164, v164, v222
  v_add_f32 v165, v165, v223
  v_add_f32 v166, v166, v224
  v_add_f32 v167, v167, v225
  s_waitcnt lgkmcnt(1)
  v_add_f32 v168, v168, v226
  s_waitcnt vmcnt(2)
  s_barrier
  v_mfma_f32_32x32x16_bf16 v[192:207], v[32:35], v[148:151], v[192:207]
  ds_read_b128 v[132:135], v120 offset:16384
  v_add_f32 v169, v169, v227
  v_add_f32 v170, v170, v228
  v_add_f32 v171, v171, v229
  v_fma_f32 v164, v164, v240, v230
  v_fma_f32 v165, v165, v240, v231
  v_fma_f32 v166, v166, v240, v232
  v_fma_f32 v167, v167, v240, v233
  s_waitcnt lgkmcnt(1)
  v_mfma_f32_32x32x16_bf16 v[192:207], v[36:39], v[156:159], v[192:207]
  ds_read_b128 v[140:143], v120 offset:17408
  v_fma_f32 v168, v168, v240, v234
  v_fma_f32 v169, v169, v240, v235
  v_fma_f32 v170, v170, v240, v236
  v_fma_f32 v171, v171, v240, v237
  v_mul_f32 v230, 0xbfb8aa3b, v164
  v_mul_f32 v231, 0xbfb8aa3b, v165
  v_mul_f32 v232, 0xbfb8aa3b, v166
  v_mul_f32 v233, 0xbfb8aa3b, v167
  s_waitcnt lgkmcnt(1)
  v_mfma_f32_32x32x16_bf16 v[192:207], v[40:43], v[132:135], v[192:207]
  v_mul_f32 v234, 0xbfb8aa3b, v168
  v_mul_f32 v235, 0xbfb8aa3b, v169
  v_mul_f32 v236, 0xbfb8aa3b, v170
  v_mul_f32 v237, 0xbfb8aa3b, v171
  v_exp_f32 v230, v230
  v_exp_f32 v231, v231
  ds_read_b128 v[148:151], v120 offset:18432
  s_waitcnt lgkmcnt(1)
  v_mfma_f32_32x32x16_bf16 v[192:207], v[44:47], v[140:143], v[192:207]
  v_exp_f32 v232, v232
  v_exp_f32 v233, v233
  v_exp_f32 v234, v234
  ds_read_b128 v[156:159], v120 offset:19456
  s_waitcnt vmcnt(0)
  s_barrier
  s_waitcnt lgkmcnt(1)
  v_mfma_f32_32x32x16_bf16 v[192:207], v[48:51], v[148:151], v[192:207]
  v_exp_f32 v235, v235
  v_exp_f32 v236, v236
  v_exp_f32 v237, v237
  v_add_f32 v230, 1.0, v230
  v_add_f32 v231, 1.0, v231
  ds_read_b128 v[132:135], v121 offset:0
  s_waitcnt lgkmcnt(1)
  v_mfma_f32_32x32x16_bf16 v[192:207], v[52:55], v[156:159], v[192:207]
  v_add_f32 v232, 1.0, v232
  v_add_f32 v233, 1.0, v233
  v_add_f32 v234, 1.0, v234
  v_add_f32 v235, 1.0, v235
  v_add_f32 v236, 1.0, v236
  v_add_f32 v237, 1.0, v237
  v_rcp_f32 v230, v230
  ds_read_b128 v[140:143], v121 offset:1024
  s_waitcnt lgkmcnt(1)
  v_mfma_f32_32x32x16_bf16 v[192:207], v[56:59], v[132:135], v[192:207]
  v_rcp_f32 v231, v231
  v_rcp_f32 v232, v232
  v_rcp_f32 v233, v233
  v_rcp_f32 v234, v234
  ds_read_b128 v[148:151], v121 offset:2048
  s_waitcnt lgkmcnt(1)
  v_mfma_f32_32x32x16_bf16 v[192:207], v[60:63], v[140:143], v[192:207]
  v_rcp_f32 v235, v235
  v_rcp_f32 v236, v236
  v_rcp_f32 v237, v237
  v_mul_f32 v164, v164, v230
  ds_read_b128 v[156:159], v121 offset:3072
  s_waitcnt lgkmcnt(1)
  v_mfma_f32_32x32x16_bf16 v[192:207], v[64:67], v[148:151], v[192:207]
  v_mul_f32 v165, v165, v231
  v_mul_f32 v166, v166, v232
  v_mul_f32 v167, v167, v233
  v_mul_f32 v168, v168, v234
  v_mul_f32 v169, v169, v235
  v_mul_f32 v170, v170, v236
  v_mul_f32 v171, v171, v237
  s_waitcnt lgkmcnt(0)
  v_mfma_f32_32x32x16_bf16 v[192:207], v[68:71], v[156:159], v[192:207]
  s_cmp_ge_u32 s42, 4
  s_cbranch_scc1 L_xa_51
  s_nop 9
  ds_write_b128 v124, v[200:203] offset:16384
  ds_write_b128 v124, v[204:207] offset:17408
  s_waitcnt lgkmcnt(0)
  s_branch L_xb_52
L_xa_51:
  s_nop 9
  ds_write_b128 v124, v[192:195] offset:16384
  ds_write_b128 v124, v[196:199] offset:17408
  s_waitcnt lgkmcnt(0)
  v_mov_b32 v192, v200
  v_mov_b32 v193, v201
  v_mov_b32 v194, v202
  v_mov_b32 v195, v203
  v_mov_b32 v196, v204
  v_mov_b32 v197, v205
  v_mov_b32 v198, v206
  v_mov_b32 v199, v207
L_xb_52:
  s_barrier
  ds_read_b128 v[222:225], v125 offset:16384
  ds_read_b128 v[226:229], v125 offset:17408
  s_waitcnt lgkmcnt(1)
  v_add_f32 v192, v192, v222
  v_add_f32 v193, v193, v223
  v_add_f32 v194, v194, v224
  v_add_f32 v195, v195, v225
  s_waitcnt lgkmcnt(0)
  v_add_f32 v196, v196, v226
  v_add_f32 v197, v197, v227
  v_add_f32 v198, v198, v228
  v_add_f32 v199, v199, v229
  v_mul_f32 v192, v192, v164
  v_mul_f32 v193, v193, v165
  v_mul_f32 v194, v194, v166
  v_mul_f32 v195, v195, v167
  v_mul_f32 v196, v196, v168
  v_mul_f32 v197, v197, v169
  v_mul_f32 v198, v198, v170
  v_mul_f32 v199, v199, v171
  v_cvt_pk_bf16_f32 v192, v192, v193
  v_cvt_pk_bf16_f32 v193, v194, v195
  v_cvt_pk_bf16_f32 v194, v196, v197
  v_cvt_pk_bf16_f32 v195, v198, v199
  ds_write_b64 v250, v[192:193]
  ds_write_b64 v250, v[194:195] offset:16
  v_lshlrev_b32 v230, 16, v212
  v_and_b32 v231, s74, v212
  v_lshlrev_b32 v232, 16, v213
  v_and_b32 v233, s74, v213
  v_lshlrev_b32 v234, 16, v214
  v_and_b32 v235, s74, v214
  v_lshlrev_b32 v236, 16, v215
  v_and_b32 v237, s74, v215
  s_waitcnt lgkmcnt(0)
  s_barrier
  ds_read_b128 v[226:229], v251
  s_waitcnt lgkmcnt(0)
  v_lshlrev_b32 v164, 16, v226
  v_and_b32 v165, s74, v226
  v_lshlrev_b32 v166, 16, v227
  v_and_b32 v167, s74, v227
  v_lshlrev_b32 v168, 16, v228
  v_and_b32 v169, s74, v228
  v_lshlrev_b32 v170, 16, v229
  v_and_b32 v171, s74, v229
  v_add_f32 v230, v230, v164
  v_add_f32 v231, v231, v165
  v_add_f32 v232, v232, v166
  v_add_f32 v233, v233, v167
  v_add_f32 v234, v234, v168
  v_add_f32 v235, v235, v169
  v_add_f32 v236, v236, v170
  v_add_f32 v237, v237, v171
  v_cvt_pk_bf16_f32 v230, v230, v231
  v_cvt_pk_bf16_f32 v231, v232, v233
  v_cvt_pk_bf16_f32 v232, v234, v235
  v_cvt_pk_bf16_f32 v233, v236, v237
  buffer_store_dwordx4 v[230:233], v126, s[32:35], s3 offen sc1
  s_nop 1
L_end:
  s_endpgm
  L_rspin_13:
    s_nop 7
    s_mov_b32 s59, 200000
  L_rspin_13_i:
    buffer_load_dwordx2 v[20:21], v122, s[20:23], s54 offen sc1
    s_waitcnt vmcnt(0)
    v_cmp_eq_u32 vcc, 0xbf800000, v21
    s_nop 4
    s_cbranch_vccz L_rok_14
    s_sub_u32 s59, s59, 1
    s_cmp_eq_u32 s59, 0
    s_cbranch_scc1 L_rok_14
    s_branch L_rspin_13_i
  L_rspin_15:
    s_nop 7
    s_mov_b32 s59, 200000
  L_rspin_15_i:
    buffer_load_dwordx2 v[20:21], v122, s[20:23], s54 offen sc1
    s_waitcnt vmcnt(0)
    v_cmp_eq_u32 vcc, 0xbf800000, v21
    s_nop 4
    s_cbranch_vccz L_rok_16
    s_sub_u32 s59, s59, 1
    s_cmp_eq_u32 s59, 0
    s_cbranch_scc1 L_rok_16
    s_branch L_rspin_15_i
  L_rspin_43:
    s_nop 7
    s_mov_b32 s59, 200000
  L_rspin_43_i:
    buffer_load_dwordx2 v[238:239], v5, s[20:23], s73 offen sc1
    s_waitcnt vmcnt(0)
    v_cmp_eq_u32 vcc, 0xbf800000, v239
    s_nop 4
    s_cbranch_vccz L_rok_44
    s_sub_u32 s59, s59, 1
    s_cmp_eq_u32 s59, 0
    s_cbranch_scc1 L_rok_44
    s_branch L_rspin_43_i
  L_codeend:
    s_endpgm
.section .rodata,"a"
.p2align 6
.amdhsa_kernel recurrent_scan__sliding_block__mixer_channel_mlp__prompt_kernel
  .amdhsa_next_free_vgpr 256
  .amdhsa_next_free_sgpr 102
  .amdhsa_accum_offset 256
  .amdhsa_group_segment_fixed_size 0
  .amdhsa_kernarg_size 88
  .amdhsa_user_sgpr_count 2
  .amdhsa_user_sgpr_kernarg_segment_ptr 1
  .amdhsa_system_sgpr_workgroup_id_x 1
.end_amdhsa_kernel
```
